```python
import torch

def _softmax(x, axis=-1):
    return torch.softmax(x, dim=axis)
def _gelu(x):
    return torch.nn.functional.gelu(x, approximate="tanh")
def _silu(x):
    return torch.nn.functional.silu(x)
def _sigmoid(x):
    return torch.sigmoid(x)
def _layernorm(x, axis=-1, eps=1e-5):
    m = x.mean(dim=axis, keepdim=True)
    v = x.var(dim=axis, keepdim=True, unbiased=False)
    return (x - m) / torch.sqrt(v + eps)
def _scatter_add(tgt, idx, src, axis=0):
    return tgt.clone().index_add_(axis, idx, src)
def _segment_sum(src, seg, n):
    out = torch.zeros((n,) + src.shape[1:], dtype=src.dtype)
    return out.index_add_(0, seg, src)
def _pad(x, pw):
    flat = tuple(v for pair in reversed(pw) for v in pair)
    return torch.nn.functional.pad(x, flat)

kernel_name = 'recurrent_scan__spectral_fnet__dense_activation_silu__prompt'

def setup_inputs():

    _w = (lambda a: (lambda t: t.to(torch.bfloat16) if t.is_floating_point() else t)(torch.as_tensor(a)))
    def _A_setup():
        B, S, D = 1, 2048, 1024
        ns = torch.arange(S)[:, None] * torch.arange(S)[None, :]
        nd = torch.arange(D)[:, None] * torch.arange(D)[None, :]
        Ws_re = torch.cos(-2.0 * torch.pi * ns / S).to(float)
        Ws_im = torch.sin(-2.0 * torch.pi * ns / S).to(float)
        Wd_re = torch.cos(-2.0 * torch.pi * nd / D).to(float)
        Wd_im = torch.sin(-2.0 * torch.pi * nd / D).to(float)
        return {
            "x": _w((lambda *s: torch.randn(*s, dtype=torch.bfloat16) * 0.05)(B, S, D)),
            "dft_seq_re": _w(Ws_re),
            "dft_seq_im": _w(Ws_im),
            "dft_hid_re": _w(Wd_re),
            "dft_hid_im": _w(Wd_im),
        }
    _A_in = _A_setup()

    def _B_setup():
        B, S, D, F = 1, 2048, 1024, 3584
        return {
            "x": _w((lambda *s: torch.randn(*s, dtype=torch.bfloat16) * 0.05)(B, S, D)),
            "w1": _w((lambda *s: torch.randn(*s, dtype=torch.bfloat16) * 0.4)(D, F) * (D ** -0.5)),
            "w2": _w((lambda *s: torch.randn(*s, dtype=torch.bfloat16) * 0.05)(F, D) * (F ** -0.5)),
        }
    _B_in = _B_setup()

    return {
        "A_x": _A_in["x"],
        "A_dft_seq_re": _A_in["dft_seq_re"],
        "A_dft_seq_im": _A_in["dft_seq_im"],
        "A_dft_hid_re": _A_in["dft_hid_re"],
        "A_dft_hid_im": _A_in["dft_hid_im"],
        "B_x": _B_in["x"],
        "B_w1": _B_in["w1"],
        "B_w2": _B_in["w2"],
    }

def reference(A_x, A_dft_seq_re, A_dft_seq_im, A_dft_hid_re, A_dft_hid_im, B_x, B_w1, B_w2):
    def _A_ref(x, dft_seq_re, dft_seq_im, dft_hid_re, dft_hid_im):
        a = torch.einsum("bsd,ed->bse", x, dft_hid_re)
        b = torch.einsum("bsd,ed->bse", x, dft_hid_im)
        y = torch.einsum("ts,bse->bte", dft_seq_re, a) - torch.einsum("ts,bse->bte", dft_seq_im, b)
        return y

    def _B_ref(x, w1, w2):
        h = torch.einsum("bsd,df->bsf", x, w1)
        h = _silu(h)
        out = torch.einsum("bsf,fd->bsd", h, w2)
        return out

    x = A_x
    xn = _layernorm(x, axis=-1)
    s = _A_ref(xn, A_dft_seq_re, A_dft_seq_im, A_dft_hid_re, A_dft_hid_im)
    g = _silu(_B_ref(xn, B_w1, B_w2))
    return x + s * g
```

```asm
; @launch grid=(256,1,1) block=(512,1,1) lds=157952
.amdgcn_target "amdgcn-amd-amdhsa--gfx950"
.text
.globl recurrent_scan__spectral_fnet__dense_activation_silu__prompt_kernel
.p2align 8
.type recurrent_scan__spectral_fnet__dense_activation_silu__prompt_kernel,@function
recurrent_scan__spectral_fnet__dense_activation_silu__prompt_kernel:
    s_cmp_ge_u32 s2, 256
    s_cbranch_scc1 L_end
    s_load_dwordx2 s[48:49], s[0:1], 0
    s_getpc_b64 s[92:93]
L_pc0:
    s_sub_u32 s92, s92, L_pc0-recurrent_scan__spectral_fnet__dense_activation_silu__prompt_kernel
    s_subb_u32 s93, s93, 0
    s_lshr_b32 s94, s2, 3
    s_lshl_b32 s94, s94, 11
    v_lshlrev_b32 v10, 7, v0
    v_add_u32 v10, s94, v10
    v_min_u32 v10, L_end-recurrent_scan__spectral_fnet__dense_activation_silu__prompt_kernel, v10
    v_cmp_gt_u32 vcc, 16, v0
    s_and_saveexec_b64 s[94:95], vcc
    s_cbranch_execz L_noct
    global_load_dword v243, v10, s[92:93]
L_noct:
    s_mov_b64 exec, -1
    s_load_dwordx8 s[56:63], s[0:1], 48
    s_load_dwordx2 s[78:79], s[0:1], 80
    s_memrealtime s[98:99]
    v_and_b32 v1, 63, v0
    v_lshrrev_b32 v2, 6, v0
    v_lshlrev_b32 v19, 4, v1
    v_readfirstlane_b32 s3, v2
    s_and_b32 s40, s2, 3
    s_lshl_b32 s40, s40, 2
    s_bfe_u32 s80, s2, 0x20003
    s_add_u32 s40, s40, s80
    s_bfe_u32 s41, s2, 0x10002
    s_lshr_b32 s42, s2, 5
    s_lshl_b32 s43, s41, 3
    s_add_u32 s43, s43, s42
    s_lshr_b32 s44, s40, 1
    s_and_b32 s45, s40, 1
    s_and_b32 s46, s3, 3
    s_lshl_b32 s80, s3, 8
    s_add_u32 s80, s80, s2
    s_lshl_b32 s80, s80, 11
    s_waitcnt lgkmcnt(0)
    s_mov_b32 s4, s48
    s_mov_b32 s5, s49
    s_mov_b32 s6, 4194304
    s_mov_b32 s7, 0x20000
    buffer_load_dwordx4 v[184:187], v19, s[4:7], s80 offen
    buffer_load_dwordx4 v[188:191], v19, s[4:7], s80 offen offset:1024
    s_mov_b32 s8, s56
    s_mov_b32 s9, s57
    s_mov_b32 s10, 7340032
    s_mov_b32 s11, 0x20000
    v_mov_b32 v240, v19
    s_mov_b32 s12, s58
    s_mov_b32 s13, s59
    s_mov_b32 s14, 7340032
    s_mov_b32 s15, 0x20000
    s_mov_b32 s16, s60
    s_mov_b32 s17, s61
    s_mov_b32 s18, 4194304
    s_mov_b32 s19, 0x20000
    s_mov_b32 s24, s78
    s_mov_b32 s25, s79
    s_mov_b32 s26, 16777216
    s_mov_b32 s27, 0x20000
    s_add_u32 s28, s78, 16777216
    s_addc_u32 s29, s79, 0
    s_mov_b32 s30, 8388608
    s_mov_b32 s31, 0x20000
    s_add_u32 s32, s78, 25165824
    s_addc_u32 s33, s79, 0
    s_mov_b32 s34, 16777216
    s_mov_b32 s35, 0x20000
    s_mov_b32 s36, s62
    s_mov_b32 s37, s63
    s_mov_b32 s38, 256
    s_mov_b32 s39, 0x20000
    s_lshl_b32 s48, s40, 1
    s_add_u32 s48, s48, s41
    s_lshl_b32 s48, s48, 8
    s_add_u32 s78, s48, 655360
    s_lshl_b32 s48, s42, 5
    s_add_u32 s79, s78, s48
    s_lshl_b32 s48, s3, 2
    s_add_u32 s79, s79, s48
    s_lshr_b32 s100, s46, 1
    s_and_b32 s101, s46, 1
    v_mov_b32 v242, v19
    v_mov_b32 v58, 0
    s_cmp_ge_u32 s3, 4
    s_cbranch_scc1 L_hpre
    v_mul_u32_u24 v10, 4682, v1
    v_lshrrev_b32 v10, 16, v10
    v_mul_u32_u24 v11, 14, v10
    v_sub_u32 v11, v1, v11
    v_lshrrev_b32 v12, 1, v10
    v_and_b32 v10, 1, v10
    v_lshl_add_u32 v10, v10, 3, v12
    s_mov_b32 s56, 458752
    v_mul_lo_u32 v10, v10, s56
    v_lshl_add_u32 v242, v11, 7, v10
    s_mul_i32 s56, s2, 1792
    v_add_u32 v242, s56, v242
    v_cmp_gt_u32 vcc, 56, v1
    v_bfrev_b32 v10, 1
    s_nop 0
    v_cndmask_b32 v242, v10, v242, vcc
    s_cmp_ge_u32 s46, 2
    s_cselect_b32 s49, 1, 0
    s_and_b32 s49, s49, s46
    s_xor_b32 s49, s49, 1
    s_mul_i32 s49, s49, 917504
    s_cmp_ge_u32 s46, 2
    s_cselect_b64 s[62:63], -1, 0
    v_cndmask_b32 v11, v10, v242, s[62:63]
    buffer_load_dword v241, v11, s[8:11], s49 offen
    v_and_b32 v10, 15, v1
    v_lshrrev_b32 v11, 4, v1
    v_and_b32 v12, 7, v1
    v_xor_b32 v11, v11, v12
    v_lshlrev_b32 v2, 7, v10
    v_lshl_add_u32 v2, v11, 4, v2
    s_lshl_b32 s48, s100, 13
    v_add_u32 v2, s48, v2
    v_xor_b32 v15, 64, v2
    v_lshrrev_b32 v10, 2, v1
    v_mul_u32_u24 v10, 448, v10
    v_and_b32 v11, 3, v1
    v_lshl_add_u32 v10, v11, 3, v10
    v_add_u32 v10, 16384, v10
    v_bfe_u32 v11, v1, 4, 1
    v_lshlrev_b32 v11, 5, v11
    s_mul_i32 s49, s101, 192
    v_add_u32 v3, v10, v11
    v_add_u32 v3, s49, v3
    v_sub_u32 v4, v10, v11
    v_add_u32 v4, s49, v4
    s_lshl_b32 s50, s101, 5
    v_xor_b32 v5, s50, v11
    v_add_u32 v5, v10, v5
    v_add_u32 v5, 384, v5
    s_add_u32 s97, s46, 2
    s_mul_i32 s97, s97, 917504
    v_bfrev_b32 v10, 1
    v_cndmask_b32 v242, v242, v10, s[62:63]
    v_lshrrev_b32 v10, 4, v1
    v_lshlrev_b32 v10, 4, v10
    s_mul_i32 s48, s101, 384
    s_add_u32 s48, s48, 137216
    v_add_u32 v252, s48, v10
    s_lshl_b32 s48, s101, 6
    s_add_u32 s48, s48, 137984
    v_add_u32 v253, s48, v10
    s_and_b32 s94, s40, 7
    s_cmp_eq_u32 s100, 0
    s_cselect_b32 s94, s94, 99
    s_mov_b32 s95, 0
    s_mov_b32 s47, 0
    v_mov_b32 v6, v2
    v_mov_b32 v7, v3
    v_mov_b32 v8, v4
    v_mov_b32 v9, v5
    v_mov_b32 v14, v15
    s_branch L_join
L_hpre:
    v_lshrrev_b32 v10, 3, v1
    v_and_b32 v11, 7, v1
    v_xor_b32 v11, v11, v10
    v_lshlrev_b32 v2, 19, v10
    v_lshl_add_u32 v2, v11, 4, v2
    s_lshl_b32 s48, s45, 4
    s_lshl_b32 s49, s46, 2
    s_add_u32 s48, s48, s49
    s_lshl_b32 s48, s48, 3
    s_add_u32 s48, s48, s44
    s_lshl_b32 s48, s48, 11
    s_lshr_b32 s82, s40, 3
    s_mul_i32 s83, s82, 3670016
    s_lshl_b32 s82, s82, 10
    s_add_u32 s84, s48, s82
    s_sub_u32 s85, s48, s82
    s_lshl_b32 s96, s46, 12
    s_lshl_b32 s48, s2, 3
    s_add_u32 s48, s48, s46
    s_cmp_lg_u32 s48, 1
    s_cbranch_scc1 L_noepoch
    v_mov_b32 v10, 0
    s_or_b32 s48, s98, 1
    v_mov_b32 v11, s48
    s_mov_b64 exec, 1
    buffer_store_dword v11, v10, s[36:39], 0 offen sc1
    s_mov_b64 exec, -1
L_noepoch:
    s_lshr_b32 s49, s46, 1
    s_lshl_b32 s49, s49, 5
    s_and_b32 s50, s46, 1
    s_lshl_b32 s50, s50, 2
    s_add_u32 s49, s49, s50
    s_mul_i32 s49, s49, 7168
    s_mul_i32 s50, s43, 448
    s_add_u32 s49, s49, s50
    v_cmp_lt_u32 vcc, 27, v1
    v_subrev_u32 v10, 28, v1
    v_mov_b32 v11, 7168
    v_cndmask_b32 v10, v1, v10, vcc
    v_cndmask_b32 v11, 0, v11, vcc
    v_add_u32 v11, s49, v11
    v_lshl_add_u32 v3, v10, 4, v11
    v_xor_b32 v10, 2, v10
    v_lshl_add_u32 v4, v10, 4, v11
    s_mul_i32 s54, s46, 7168
    s_add_u32 s54, s54, 16384
    s_and_b32 s87, s40, 7
    v_and_b32 v10, 7, v1
    v_lshlrev_b32 v10, 8, v10
    v_add_u32 v10, s2, v10
    v_cvt_f32_u32 v10, v10
    v_mul_f32 v10, 0x3a000000, v10
    v_lshrrev_b32 v11, 5, v1
    v_lshlrev_b32 v11, 5, v11
    v_bfe_u32 v12, v1, 3, 2
    v_lshl_add_u32 v11, v12, 2, v11
    s_lshl_b32 s60, s46, 6
    v_add_u32 v11, s60, v11
    v_cvt_f32_u32 v11, v11
    v_mul_f32 v11, v11, v10
    v_fmamk_f32 v20, v10, 0x00000000, v11
    v_fmamk_f32 v21, v10, 0x3f800000, v11
    v_fmamk_f32 v22, v10, 0x40000000, v11
    v_fmamk_f32 v23, v10, 0x40400000, v11
    v_fmamk_f32 v24, v10, 0x41800000, v11
    v_fmamk_f32 v25, v10, 0x41880000, v11
    v_fmamk_f32 v26, v10, 0x41900000, v11
    v_fmamk_f32 v27, v10, 0x41980000, v11
    v_fract_f32 v20, v20
    v_fract_f32 v21, v21
    v_fract_f32 v22, v22
    v_fract_f32 v23, v23
    v_fract_f32 v24, v24
    v_fract_f32 v25, v25
    v_fract_f32 v26, v26
    v_fract_f32 v27, v27
    v_cos_f32 v28, v20
    v_sin_f32 v20, v20
    v_cos_f32 v29, v21
    v_sin_f32 v21, v21
    v_cos_f32 v30, v22
    v_sin_f32 v22, v22
    v_cos_f32 v31, v23
    v_sin_f32 v23, v23
    v_cos_f32 v32, v24
    v_sin_f32 v24, v24
    v_cos_f32 v33, v25
    v_sin_f32 v25, v25
    v_cos_f32 v34, v26
    v_sin_f32 v26, v26
    v_cos_f32 v35, v27
    v_sin_f32 v27, v27
    v_cvt_pk_bf16_f32 v120, v28, v29
    v_cvt_pk_bf16_f32 v121, v30, v31
    v_cvt_pk_bf16_f32 v122, v32, v33
    v_cvt_pk_bf16_f32 v123, v34, v35
    v_cvt_pk_bf16_f32 v124, -v20, -v21
    v_cvt_pk_bf16_f32 v125, -v22, -v23
    v_cvt_pk_bf16_f32 v126, -v24, -v25
    v_cvt_pk_bf16_f32 v127, -v26, -v27
    v_mul_u32_u24 v10, 4682, v1
    v_lshrrev_b32 v10, 16, v10
    v_mul_u32_u24 v11, 14, v10
    v_sub_u32 v11, v1, v11
    v_lshrrev_b32 v12, 1, v10
    v_and_b32 v10, 1, v10
    v_lshl_add_u32 v10, v10, 3, v12
    s_mov_b32 s56, 458752
    v_mul_lo_u32 v10, v10, s56
    v_lshl_add_u32 v14, v11, 7, v10
    s_mul_i32 s56, s2, 1792
    v_add_u32 v14, s56, v14
    v_cmp_gt_u32 vcc, 56, v1
    v_bfrev_b32 v10, 1
    s_nop 0
    v_cndmask_b32 v14, v10, v14, vcc
    v_bfrev_b32 v17, 1
    v_lshlrev_b32 v15, 7, v1
    v_cmp_gt_u32 vcc, 56, v1
    s_and_b32 s59, s46, 1
    s_mul_i32 s80, s2, 28672
    v_cndmask_b32 v15, v17, v15, vcc
L_join:
    v_and_b32 v232, 31, v1
    v_cvt_f32_u32 v232, v232
    v_mul_f32 v232, 0x3a800000, v232
    v_lshrrev_b32 v233, 5, v1
    v_lshlrev_b32 v233, 2, v233
    s_lshr_b32 s60, s3, 1
    s_lshl_b32 s60, s60, 3
    s_and_b32 s61, s3, 1
    s_lshl_b32 s61, s61, 1
    s_add_u32 s60, s60, s61
    v_add_u32 v233, s60, v233
    v_cvt_f32_u32 v233, v233
    v_mul_f32 v233, v233, v232
    v_add_f32 v232, v233, v232
    v_cos_f32 v128, v233
    v_cos_f32 v129, v232
    v_sin_f32 v144, v233
    v_sin_f32 v145, v232
    v_mul_f32 v233, 0x42000000, v233
    v_mul_f32 v232, 0x42000000, v232
    v_fract_f32 v233, v233
    v_fract_f32 v232, v232
    v_cos_f32 v234, v233
    v_cos_f32 v235, v232
    v_sin_f32 v236, v233
    v_sin_f32 v237, v232
    s_lshr_b32 s60, s3, 1
    s_lshl_b32 s60, s60, 10
    s_lshl_b32 s61, s61, 2
    s_add_u32 s60, s60, s61
    s_add_u32 s60, s60, 108544
    v_add_u32 v238, s60, v240
    s_lshr_b32 s60, s3, 2
    s_lshl_b32 s60, s60, 10
    s_lshl_b32 s61, s46, 2
    s_add_u32 s60, s60, s61
    s_add_u32 s60, s60, 116736
    v_add_u32 v239, s60, v240
    v_cvt_pk_f16_f32 v234, v234, v235
    v_cvt_pk_f16_f32 v235, v236, v237
    v_cvt_pk_f16_f32 v236, -v236, -v237
    ds_write_b64 v238, v[128:129]
    ds_write_b64 v238, v[144:145] offset:4096
    ds_write_b32 v239, v234
    ds_write_b32 v239, v235 offset:2048
    ds_write_b32 v239, v236 offset:4096
    v_lshrrev_b32 v10, 2, v1
    v_mul_u32_u24 v10, 576, v10
    v_and_b32 v11, 1, v1
    v_mul_u32_u24 v11, 288, v11
    v_add_u32 v10, v10, v11
    v_bfe_u32 v11, v1, 1, 1
    v_lshl_add_u32 v10, v11, 3, v10
    s_lshl_b32 s60, s3, 4
    s_add_u32 s60, s60, 90112
    v_add_u32 v10, s60, v10
    v_lshrrev_b32 v11, 2, v0
    v_mul_u32_u24 v11, 144, v11
    v_and_b32 v12, 3, v0
    v_lshl_add_u32 v11, v12, 2, v11
    v_add_u32 v11, 90112, v11
    v_lshrrev_b32 v12, 4, v0
    v_lshlrev_b32 v12, 6, v12
    v_bfe_u32 v13, v0, 1, 1
    v_lshl_add_u32 v12, v13, 5, v12
    v_bfe_u32 v13, v0, 2, 2
    v_lshl_add_u32 v12, v13, 3, v12
    v_and_b32 v13, 1, v0
    v_lshl_add_u32 v12, v13, 2, v12
    v_add_u32 v12, 141568, v12
    s_lshl_b32 s60, s3, 3
    s_add_u32 s60, s60, 141312
    v_mov_b32 v230, s60
    v_mov_b32 v231, 0x3f803f80
    s_cmp_ge_u32 s3, 4
    s_cbranch_scc1 L_hw
    s_waitcnt vmcnt(1)
    s_branch L_hw2
L_hw:
    s_waitcnt vmcnt(0)
    s_add_u32 m0, s96, 0
    s_add_u32 s55, s84, 0
    buffer_load_dwordx4 v2, s[4:7], s55 offen lds
    s_add_u32 m0, s96, 1024
    s_add_u32 s55, s84, 16384
    buffer_load_dwordx4 v2, s[4:7], s55 offen lds
    s_add_u32 m0, s96, 2048
    s_add_u32 s55, s84, 32768
    buffer_load_dwordx4 v2, s[4:7], s55 offen lds
    s_add_u32 m0, s96, 3072
    s_add_u32 s55, s84, 49152
    buffer_load_dwordx4 v2, s[4:7], s55 offen lds
    s_mov_b32 exec_hi, 0xffffff
    s_add_u32 m0, s54, 0
    s_add_u32 s55, s83, 0
    buffer_load_dwordx4 v3, s[8:11], s55 offen  lds
    s_add_u32 m0, s54, 896
    s_add_u32 s55, s83, 14336
    buffer_load_dwordx4 v3, s[8:11], s55 offen  lds
    s_add_u32 m0, s54, 1792
    s_add_u32 s55, s83, 57344
    buffer_load_dwordx4 v4, s[8:11], s55 offen  lds
    s_mov_b64 exec, -1
L_hw2:
    v_readfirstlane_b32 s62, v184
    v_lshlrev_b32 v192, 16, v184
    v_and_b32 v193, 0xffff0000, v184
    v_lshlrev_b32 v194, 16, v185
    v_and_b32 v195, 0xffff0000, v185
    v_lshlrev_b32 v196, 16, v186
    v_and_b32 v197, 0xffff0000, v186
    v_lshlrev_b32 v198, 16, v187
    v_and_b32 v199, 0xffff0000, v187
    v_lshlrev_b32 v200, 16, v188
    v_and_b32 v201, 0xffff0000, v188
    v_lshlrev_b32 v202, 16, v189
    v_and_b32 v203, 0xffff0000, v189
    v_lshlrev_b32 v204, 16, v190
    v_and_b32 v205, 0xffff0000, v190
    v_lshlrev_b32 v206, 16, v191
    v_and_b32 v207, 0xffff0000, v191
    s_lshl_b32 s62, s62, 16
    s_mov_b32 s63, s62
    v_pk_add_f32 v[208:209], v[192:193], s[62:63] neg_lo:[0,1] neg_hi:[0,1]
    v_pk_add_f32 v[210:211], v[194:195], s[62:63] neg_lo:[0,1] neg_hi:[0,1]
    v_pk_mul_f32 v[214:215], v[208:209], v[208:209]
    v_pk_add_f32 v[212:213], v[208:209], v[210:211]
    v_pk_add_f32 v[208:209], v[196:197], s[62:63] neg_lo:[0,1] neg_hi:[0,1]
    v_pk_fma_f32 v[214:215], v[210:211], v[210:211], v[214:215]
    v_pk_add_f32 v[212:213], v[212:213], v[208:209]
    v_pk_add_f32 v[210:211], v[198:199], s[62:63] neg_lo:[0,1] neg_hi:[0,1]
    v_pk_fma_f32 v[214:215], v[208:209], v[208:209], v[214:215]
    v_pk_add_f32 v[212:213], v[212:213], v[210:211]
    v_pk_add_f32 v[208:209], v[200:201], s[62:63] neg_lo:[0,1] neg_hi:[0,1]
    v_pk_fma_f32 v[214:215], v[210:211], v[210:211], v[214:215]
    v_pk_add_f32 v[212:213], v[212:213], v[208:209]
    v_pk_add_f32 v[210:211], v[202:203], s[62:63] neg_lo:[0,1] neg_hi:[0,1]
    v_pk_fma_f32 v[214:215], v[208:209], v[208:209], v[214:215]
    v_pk_add_f32 v[212:213], v[212:213], v[210:211]
    v_pk_add_f32 v[208:209], v[204:205], s[62:63] neg_lo:[0,1] neg_hi:[0,1]
    v_pk_fma_f32 v[214:215], v[210:211], v[210:211], v[214:215]
    v_pk_add_f32 v[212:213], v[212:213], v[208:209]
    v_pk_add_f32 v[210:211], v[206:207], s[62:63] neg_lo:[0,1] neg_hi:[0,1]
    v_pk_fma_f32 v[214:215], v[208:209], v[208:209], v[214:215]
    v_pk_add_f32 v[212:213], v[212:213], v[210:211]
    v_pk_fma_f32 v[214:215], v[210:211], v[210:211], v[214:215]
    v_add_f32 v224, v212, v213
    v_add_f32 v225, v214, v215
    s_nop 0
    v_add_f32_dpp v224, v224, v224 quad_perm:[1,0,3,2] row_mask:0xf bank_mask:0xf
    v_add_f32_dpp v225, v225, v225 quad_perm:[1,0,3,2] row_mask:0xf bank_mask:0xf
    s_nop 0
    v_add_f32_dpp v224, v224, v224 quad_perm:[2,3,0,1] row_mask:0xf bank_mask:0xf
    v_add_f32_dpp v225, v225, v225 quad_perm:[2,3,0,1] row_mask:0xf bank_mask:0xf
    s_nop 0
    v_add_f32_dpp v224, v224, v224 row_half_mirror row_mask:0xf bank_mask:0xf
    v_add_f32_dpp v225, v225, v225 row_half_mirror row_mask:0xf bank_mask:0xf
    s_nop 0
    v_add_f32_dpp v224, v224, v224 row_mirror row_mask:0xf bank_mask:0xf
    v_add_f32_dpp v225, v225, v225 row_mirror row_mask:0xf bank_mask:0xf
    s_nop 0
    v_mov_b32 v226, v224
    v_mov_b32 v227, v225
    s_nop 0
    s_nop 0
    v_permlane16_swap_b32 v226, v224
    v_permlane16_swap_b32 v227, v225
    v_add_f32 v224, v226, v224
    v_add_f32 v225, v227, v225
    v_mov_b32 v226, v224
    v_mov_b32 v227, v225
    s_nop 0
    s_nop 0
    v_permlane32_swap_b32 v226, v224
    v_permlane32_swap_b32 v227, v225
    v_add_f32 v224, v226, v224
    v_add_f32 v225, v227, v225
    v_mul_f32 v224, 0x3a800000, v224
    v_mul_f32 v225, 0x3a800000, v225
    v_fma_f32 v225, -v224, v224, v225
    v_max_f32 v225, 0, v225
    v_add_f32 v224, s62, v224
    v_cvt_pk_bf16_f32 v225, v224, v225
    v_lshlrev_b32 v224, 16, v225
    v_and_b32 v225, 0xffff0000, v225
    v_add_f32 v225, 0x3727c5ac, v225
    v_cvt_pk_bf16_f32 v225, v225, v225
    v_and_b32 v225, 0xffff0000, v225
    v_sqrt_f32 v225, v225
    s_nop 0
    v_cvt_pk_bf16_f32 v225, v225, v225
    v_and_b32 v225, 0xffff0000, v225
    v_rcp_f32 v226, v225
    s_nop 0
    v_mul_f32_e64 v227, -v224, v226
    ds_write_b64 v230, v[224:225]
    v_pk_fma_f32 v[192:193], v[192:193], v[226:227], v[226:227] op_sel:[0,0,1] op_sel_hi:[1,0,1]
    v_pk_fma_f32 v[194:195], v[194:195], v[226:227], v[226:227] op_sel:[0,0,1] op_sel_hi:[1,0,1]
    v_pk_fma_f32 v[196:197], v[196:197], v[226:227], v[226:227] op_sel:[0,0,1] op_sel_hi:[1,0,1]
    v_pk_fma_f32 v[198:199], v[198:199], v[226:227], v[226:227] op_sel:[0,0,1] op_sel_hi:[1,0,1]
    v_pk_fma_f32 v[200:201], v[200:201], v[226:227], v[226:227] op_sel:[0,0,1] op_sel_hi:[1,0,1]
    v_pk_fma_f32 v[202:203], v[202:203], v[226:227], v[226:227] op_sel:[0,0,1] op_sel_hi:[1,0,1]
    v_pk_fma_f32 v[204:205], v[204:205], v[226:227], v[226:227] op_sel:[0,0,1] op_sel_hi:[1,0,1]
    v_pk_fma_f32 v[206:207], v[206:207], v[226:227], v[226:227] op_sel:[0,0,1] op_sel_hi:[1,0,1]
    v_cvt_pk_bf16_f32 v184, v192, v193
    v_cvt_pk_bf16_f32 v185, v194, v195
    v_cvt_pk_bf16_f32 v186, v196, v197
    v_cvt_pk_bf16_f32 v187, v198, v199
    v_cvt_pk_bf16_f32 v188, v200, v201
    v_cvt_pk_bf16_f32 v189, v202, v203
    v_cvt_pk_bf16_f32 v190, v204, v205
    v_cvt_pk_bf16_f32 v191, v206, v207
    ds_write_b64 v10, v[184:185]
    ds_write_b64 v10, v[186:187] offset:144
    ds_write_b64 v10, v[188:189] offset:9216
    ds_write_b64 v10, v[190:191] offset:9360
    s_cmp_lt_u32 s3, 4
    s_cbranch_scc1 ho_1
    s_mov_b32 exec_hi, 0xffffff
    s_add_u32 m0, s54, 2688
    s_add_u32 s55, s83, 71680
    buffer_load_dwordx4 v4, s[8:11], s55 offen  lds
    s_add_u32 m0, s54, 3584
    s_add_u32 s55, s83, 114688
    buffer_load_dwordx4 v3, s[8:11], s55 offen  lds
    s_add_u32 m0, s54, 4480
    s_add_u32 s55, s83, 129024
    buffer_load_dwordx4 v3, s[8:11], s55 offen  lds
    s_add_u32 m0, s54, 5376
    s_add_u32 s55, s83, 172032
    buffer_load_dwordx4 v4, s[8:11], s55 offen  lds
    s_add_u32 m0, s54, 6272
    s_add_u32 s55, s83, 186368
    buffer_load_dwordx4 v4, s[8:11], s55 offen  lds
    s_mov_b64 exec, -1
    s_add_u32 m0, s96, 45056
    s_add_u32 s55, s84, 128
    buffer_load_dwordx4 v2, s[4:7], s55 offen lds
    s_add_u32 m0, s96, 46080
    s_add_u32 s55, s84, 16512
    buffer_load_dwordx4 v2, s[4:7], s55 offen lds
    s_add_u32 m0, s96, 47104
    s_add_u32 s55, s84, 32896
    buffer_load_dwordx4 v2, s[4:7], s55 offen lds
    s_add_u32 m0, s96, 48128
    s_add_u32 s55, s84, 49280
    buffer_load_dwordx4 v2, s[4:7], s55 offen lds
ho_1:
    s_mov_b32 s60, 0x3f3504f3
    s_mov_b32 s61, s60
    s_waitcnt lgkmcnt(0)
    s_barrier
    ds_read_b32 v184, v11 offset:0
    ds_read_b32 v185, v11 offset:16
    ds_read_b32 v186, v11 offset:32
    ds_read_b32 v187, v11 offset:48
    ds_read_b32 v188, v11 offset:64
    ds_read_b32 v189, v11 offset:80
    ds_read_b32 v190, v11 offset:96
    ds_read_b32 v191, v11 offset:112
    s_waitcnt lgkmcnt(0)
    v_lshlrev_b32 v192, 16, v184
    v_and_b32 v193, 0xffff0000, v184
    v_lshlrev_b32 v194, 16, v185
    v_and_b32 v195, 0xffff0000, v185
    v_lshlrev_b32 v196, 16, v186
    v_and_b32 v197, 0xffff0000, v186
    v_lshlrev_b32 v198, 16, v187
    v_and_b32 v199, 0xffff0000, v187
    v_lshlrev_b32 v200, 16, v188
    v_and_b32 v201, 0xffff0000, v188
    v_lshlrev_b32 v202, 16, v189
    v_and_b32 v203, 0xffff0000, v189
    v_lshlrev_b32 v204, 16, v190
    v_and_b32 v205, 0xffff0000, v190
    v_lshlrev_b32 v206, 16, v191
    v_and_b32 v207, 0xffff0000, v191
    v_pk_add_f32 v[208:209], v[192:193], v[200:201]
    v_pk_add_f32 v[210:211], v[192:193], v[200:201] neg_lo:[0,1] neg_hi:[0,1]
    v_pk_add_f32 v[212:213], v[196:197], v[204:205]
    v_pk_add_f32 v[214:215], v[196:197], v[204:205] neg_lo:[0,1] neg_hi:[0,1]
    v_pk_add_f32 v[216:217], v[194:195], v[202:203]
    v_pk_add_f32 v[218:219], v[194:195], v[202:203] neg_lo:[0,1] neg_hi:[0,1]
    v_pk_add_f32 v[220:221], v[198:199], v[206:207]
    v_pk_add_f32 v[222:223], v[198:199], v[206:207] neg_lo:[0,1] neg_hi:[0,1]
    v_pk_add_f32 v[192:193], v[208:209], v[212:213]
    v_pk_add_f32 v[200:201], v[208:209], v[212:213] neg_lo:[0,1] neg_hi:[0,1]
    v_pk_add_f32 v[194:195], v[216:217], v[220:221]
    v_pk_add_f32 v[202:203], v[220:221], v[216:217] neg_lo:[0,1] neg_hi:[0,1]
    v_pk_add_f32 v[196:197], v[218:219], v[222:223] neg_lo:[0,1] neg_hi:[0,1]
    v_pk_add_f32 v[198:199], v[218:219], v[222:223]
    v_pk_add_f32 v[208:209], v[192:193], v[194:195]
    v_pk_add_f32 v[212:213], v[192:193], v[194:195] neg_lo:[0,1] neg_hi:[0,1]
    v_pk_fma_f32 v[216:217], v[196:197], s[60:61], v[210:211]
    v_pk_fma_f32 v[218:219], v[198:199], s[60:61], v[214:215] neg_lo:[1,0,1] neg_hi:[1,0,1]
    v_pk_fma_f32 v[220:221], v[196:197], s[60:61], v[210:211] neg_lo:[1,0,0] neg_hi:[1,0,0]
    v_pk_fma_f32 v[222:223], v[198:199], s[60:61], v[214:215] neg_lo:[1,0,0] neg_hi:[1,0,0]
    v_cvt_pk_f16_f32 v184, v208, v209
    v_cvt_pk_f16_f32 v185, v212, v213
    v_cvt_pk_f16_f32 v186, v216, v217
    v_cvt_pk_f16_f32 v187, v218, v219
    v_cvt_pk_f16_f32 v188, v200, v201
    v_cvt_pk_f16_f32 v189, v202, v203
    v_cvt_pk_f16_f32 v190, v220, v221
    v_cvt_pk_f16_f32 v191, v222, v223
    ds_write_b32 v12, v184 offset:0
    ds_write_b32 v12, v185 offset:2048
    ds_write_b32 v12, v186 offset:4096
    ds_write_b32 v12, v187 offset:6144
    ds_write_b32 v12, v188 offset:8192
    ds_write_b32 v12, v189 offset:10240
    ds_write_b32 v12, v190 offset:12288
    ds_write_b32 v12, v191 offset:14336
    s_cmp_lt_u32 s3, 4
    s_cbranch_scc1 ho_2
    v_add_u32 v11, 108544, v240
    ds_read_b128 v[128:131], v11 offset:0
    ds_read_b128 v[132:135], v11 offset:1024
    ds_read_b128 v[136:139], v11 offset:2048
    ds_read_b128 v[140:143], v11 offset:3072
    ds_read_b128 v[144:147], v11 offset:4096
    ds_read_b128 v[148:151], v11 offset:5120
    ds_read_b128 v[152:155], v11 offset:6144
    ds_read_b128 v[156:159], v11 offset:7168
    ds_read_b128 v[160:163], v11 offset:8192
    ds_read_b128 v[164:167], v11 offset:9216
    ds_read_b128 v[168:171], v11 offset:10240
    ds_read_b128 v[172:175], v11 offset:11264
    ds_read_b128 v[176:179], v11 offset:12288
    ds_read_b128 v[180:183], v11 offset:13312
    s_mov_b32 exec_hi, 0xffffff
    s_add_u32 m0, s54, 45056
    s_add_u32 s55, s83, 458752
    buffer_load_dwordx4 v3, s[8:11], s55 offen  lds
    s_add_u32 m0, s54, 45952
    s_add_u32 s55, s83, 473088
    buffer_load_dwordx4 v3, s[8:11], s55 offen  lds
    s_add_u32 m0, s54, 46848
    s_add_u32 s55, s83, 516096
    buffer_load_dwordx4 v4, s[8:11], s55 offen  lds
    s_add_u32 m0, s54, 47744
    s_add_u32 s55, s83, 530432
    buffer_load_dwordx4 v4, s[8:11], s55 offen  lds
    s_add_u32 m0, s54, 48640
    s_add_u32 s55, s83, 573440
    buffer_load_dwordx4 v3, s[8:11], s55 offen  lds
    s_add_u32 m0, s54, 49536
    s_add_u32 s55, s83, 587776
    buffer_load_dwordx4 v3, s[8:11], s55 offen  lds
    s_add_u32 m0, s54, 50432
    s_add_u32 s55, s83, 630784
    buffer_load_dwordx4 v4, s[8:11], s55 offen  lds
    s_add_u32 m0, s54, 51328
    s_add_u32 s55, s83, 645120
    buffer_load_dwordx4 v4, s[8:11], s55 offen  lds
    s_mov_b64 exec, -1
    buffer_load_dword v59, v58, s[36:39], 0 offen sc1
ho_2:
    s_cmp_ge_u32 s3, 4
    s_cbranch_scc0 L_consumer
    s_waitcnt vmcnt(13) lgkmcnt(0)
    s_barrier
    v_add_u32 v20, 141312, v19
    ds_read_b128 v[48:51], v20
    s_waitcnt lgkmcnt(0)
    s_add_u32 m0, s96, 90112
    s_add_u32 s55, s84, 256
    buffer_load_dwordx4 v2, s[4:7], s55 offen lds
    s_add_u32 m0, s96, 91136
    s_add_u32 s55, s84, 16640
    buffer_load_dwordx4 v2, s[4:7], s55 offen lds
    s_add_u32 m0, s96, 92160
    s_add_u32 s55, s84, 33024
    buffer_load_dwordx4 v2, s[4:7], s55 offen lds
    s_add_u32 m0, s96, 93184
    s_add_u32 s55, s84, 49408
    buffer_load_dwordx4 v2, s[4:7], s55 offen lds
    s_mov_b32 exec_hi, 0xffffff
    s_add_u32 m0, s54, 90112
    s_add_u32 s55, s83, 917504
    buffer_load_dwordx4 v3, s[8:11], s55 offen  lds
    s_add_u32 m0, s54, 91008
    s_add_u32 s55, s83, 931840
    buffer_load_dwordx4 v3, s[8:11], s55 offen  lds
    s_add_u32 m0, s54, 91904
    s_add_u32 s55, s83, 974848
    buffer_load_dwordx4 v4, s[8:11], s55 offen  lds
    s_add_u32 m0, s54, 92800
    s_add_u32 s55, s83, 989184
    buffer_load_dwordx4 v4, s[8:11], s55 offen  lds
    s_add_u32 m0, s54, 93696
    s_add_u32 s55, s83, 1032192
    buffer_load_dwordx4 v3, s[8:11], s55 offen  lds
    s_add_u32 m0, s54, 94592
    s_add_u32 s55, s83, 1046528
    buffer_load_dwordx4 v3, s[8:11], s55 offen  lds
    s_add_u32 m0, s54, 95488
    s_add_u32 s55, s83, 1089536
    buffer_load_dwordx4 v4, s[8:11], s55 offen  lds
    s_add_u32 m0, s54, 96384
    s_add_u32 s55, s83, 1103872
    buffer_load_dwordx4 v4, s[8:11], s55 offen  lds
    s_mov_b64 exec, -1
    s_cmp_eq_u32 s46, 0
    s_cselect_b64 s[62:63], -1, 0
    v_cndmask_b32 v18, v17, v14, s[62:63]
    s_mov_b32 s55, 1835008
    buffer_load_dword v16, v18, s[8:11], s55 offen
    s_waitcnt vmcnt(14) lgkmcnt(0)
    s_barrier
    s_add_u32 m0, s96, 0
    s_add_u32 s55, s84, 384
    buffer_load_dwordx4 v2, s[4:7], s55 offen lds
    s_add_u32 m0, s96, 1024
    s_add_u32 s55, s84, 16768
    buffer_load_dwordx4 v2, s[4:7], s55 offen lds
    s_add_u32 m0, s96, 2048
    s_add_u32 s55, s84, 33152
    buffer_load_dwordx4 v2, s[4:7], s55 offen lds
    s_add_u32 m0, s96, 3072
    s_add_u32 s55, s84, 49536
    buffer_load_dwordx4 v2, s[4:7], s55 offen lds
    s_mov_b32 exec_hi, 0xffffff
    s_add_u32 m0, s54, 0
    s_add_u32 s55, s83, 1376256
    buffer_load_dwordx4 v3, s[8:11], s55 offen  lds
    s_add_u32 m0, s54, 896
    s_add_u32 s55, s83, 1390592
    buffer_load_dwordx4 v3, s[8:11], s55 offen  lds
    s_add_u32 m0, s54, 1792
    s_add_u32 s55, s83, 1433600
    buffer_load_dwordx4 v4, s[8:11], s55 offen  lds
    s_add_u32 m0, s54, 2688
    s_add_u32 s55, s83, 1447936
    buffer_load_dwordx4 v4, s[8:11], s55 offen  lds
    s_add_u32 m0, s54, 3584
    s_add_u32 s55, s83, 1490944
    buffer_load_dwordx4 v3, s[8:11], s55 offen  lds
    s_add_u32 m0, s54, 4480
    s_add_u32 s55, s83, 1505280
    buffer_load_dwordx4 v3, s[8:11], s55 offen  lds
    s_add_u32 m0, s54, 5376
    s_add_u32 s55, s83, 1548288
    buffer_load_dwordx4 v4, s[8:11], s55 offen  lds
    s_add_u32 m0, s54, 6272
    s_add_u32 s55, s83, 1562624
    buffer_load_dwordx4 v4, s[8:11], s55 offen  lds
    s_mov_b64 exec, -1
    s_waitcnt vmcnt(13) lgkmcnt(0)
    s_barrier
    s_add_u32 m0, s96, 45056
    s_add_u32 s55, s84, 512
    buffer_load_dwordx4 v2, s[4:7], s55 offen lds
    s_add_u32 m0, s96, 46080
    s_add_u32 s55, s84, 16896
    buffer_load_dwordx4 v2, s[4:7], s55 offen lds
    s_add_u32 m0, s96, 47104
    s_add_u32 s55, s84, 33280
    buffer_load_dwordx4 v2, s[4:7], s55 offen lds
    s_add_u32 m0, s96, 48128
    s_add_u32 s55, s84, 49664
    buffer_load_dwordx4 v2, s[4:7], s55 offen lds
    s_mov_b32 exec_hi, 0xffffff
    s_add_u32 m0, s54, 45056
    s_add_u32 s55, s83, 1835008
    buffer_load_dwordx4 v3, s[8:11], s55 offen  lds
    s_add_u32 m0, s54, 45952
    s_add_u32 s55, s83, 1849344
    buffer_load_dwordx4 v3, s[8:11], s55 offen  lds
    s_add_u32 m0, s54, 46848
    s_add_u32 s55, s83, 1892352
    buffer_load_dwordx4 v4, s[8:11], s55 offen  lds
    s_add_u32 m0, s54, 47744
    s_add_u32 s55, s83, 1906688
    buffer_load_dwordx4 v4, s[8:11], s55 offen  lds
    s_add_u32 m0, s54, 48640
    s_add_u32 s55, s83, 1949696
    buffer_load_dwordx4 v3, s[8:11], s55 offen  lds
    s_add_u32 m0, s54, 49536
    s_add_u32 s55, s83, 1964032
    buffer_load_dwordx4 v3, s[8:11], s55 offen  lds
    s_add_u32 m0, s54, 50432
    s_add_u32 s55, s83, 2007040
    buffer_load_dwordx4 v4, s[8:11], s55 offen  lds
    s_add_u32 m0, s54, 51328
    s_add_u32 s55, s83, 2021376
    buffer_load_dwordx4 v4, s[8:11], s55 offen  lds
    s_mov_b64 exec, -1
    s_cmp_eq_u32 s46, 1
    s_cselect_b64 s[62:63], -1, 0
    v_cndmask_b32 v18, v17, v14, s[62:63]
    s_mov_b32 s55, 2752512
    buffer_load_dword v16, v18, s[8:11], s55 offen
    s_waitcnt vmcnt(38)
    s_mov_b32 s73, 0
    v_readfirstlane_b32 s94, v59
    s_nop 0
    s_cmp_lg_u32 s94, 0
    s_cbranch_scc1 ep_done_4
ep_spin_3:
    buffer_load_dword v59, v58, s[36:39], 0 offen sc1
    s_waitcnt vmcnt(0)
    v_readfirstlane_b32 s94, v59
    s_nop 0
    s_cmp_lg_u32 s94, 0
    s_cbranch_scc1 ep_done_4
    s_sleep 1
    s_add_u32 s73, s73, 1
    s_cmp_lt_u32 s73, 0x8000
    s_cbranch_scc1 ep_spin_3
ep_done_4:
    v_mov_b32 v60, s94
    s_waitcnt vmcnt(13) lgkmcnt(0)
    s_barrier
    s_add_u32 m0, s96, 90112
    s_add_u32 s55, s84, 640
    buffer_load_dwordx4 v2, s[4:7], s55 offen lds
    s_add_u32 m0, s96, 91136
    s_add_u32 s55, s84, 17024
    buffer_load_dwordx4 v2, s[4:7], s55 offen lds
    s_add_u32 m0, s96, 92160
    s_add_u32 s55, s84, 33408
    buffer_load_dwordx4 v2, s[4:7], s55 offen lds
    s_add_u32 m0, s96, 93184
    s_add_u32 s55, s84, 49792
    buffer_load_dwordx4 v2, s[4:7], s55 offen lds
    s_mov_b32 exec_hi, 0xffffff
    s_add_u32 m0, s54, 90112
    s_add_u32 s55, s83, 2293760
    buffer_load_dwordx4 v3, s[8:11], s55 offen  lds
    s_add_u32 m0, s54, 91008
    s_add_u32 s55, s83, 2308096
    buffer_load_dwordx4 v3, s[8:11], s55 offen  lds
    s_add_u32 m0, s54, 91904
    s_add_u32 s55, s83, 2351104
    buffer_load_dwordx4 v4, s[8:11], s55 offen  lds
    s_add_u32 m0, s54, 92800
    s_add_u32 s55, s83, 2365440
    buffer_load_dwordx4 v4, s[8:11], s55 offen  lds
    s_add_u32 m0, s54, 93696
    s_add_u32 s55, s83, 2408448
    buffer_load_dwordx4 v3, s[8:11], s55 offen  lds
    s_add_u32 m0, s54, 94592
    s_add_u32 s55, s83, 2422784
    buffer_load_dwordx4 v3, s[8:11], s55 offen  lds
    s_add_u32 m0, s54, 95488
    s_add_u32 s55, s83, 2465792
    buffer_load_dwordx4 v4, s[8:11], s55 offen  lds
    s_add_u32 m0, s54, 96384
    s_add_u32 s55, s83, 2480128
    buffer_load_dwordx4 v4, s[8:11], s55 offen  lds
    s_mov_b64 exec, -1
    s_waitcnt vmcnt(13) lgkmcnt(0)
    s_barrier
    s_add_u32 m0, s96, 0
    s_add_u32 s55, s84, 768
    buffer_load_dwordx4 v2, s[4:7], s55 offen lds
    s_add_u32 m0, s96, 1024
    s_add_u32 s55, s84, 17152
    buffer_load_dwordx4 v2, s[4:7], s55 offen lds
    s_add_u32 m0, s96, 2048
    s_add_u32 s55, s84, 33536
    buffer_load_dwordx4 v2, s[4:7], s55 offen lds
    s_add_u32 m0, s96, 3072
    s_add_u32 s55, s84, 49920
    buffer_load_dwordx4 v2, s[4:7], s55 offen lds
    s_mov_b32 exec_hi, 0xffffff
    s_add_u32 m0, s54, 0
    s_add_u32 s55, s83, 2752512
    buffer_load_dwordx4 v3, s[8:11], s55 offen  lds
    s_add_u32 m0, s54, 896
    s_add_u32 s55, s83, 2766848
    buffer_load_dwordx4 v3, s[8:11], s55 offen  lds
    s_add_u32 m0, s54, 1792
    s_add_u32 s55, s83, 2809856
    buffer_load_dwordx4 v4, s[8:11], s55 offen  lds
    s_add_u32 m0, s54, 2688
    s_add_u32 s55, s83, 2824192
    buffer_load_dwordx4 v4, s[8:11], s55 offen  lds
    s_add_u32 m0, s54, 3584
    s_add_u32 s55, s83, 2867200
    buffer_load_dwordx4 v3, s[8:11], s55 offen  lds
    s_add_u32 m0, s54, 4480
    s_add_u32 s55, s83, 2881536
    buffer_load_dwordx4 v3, s[8:11], s55 offen  lds
    s_add_u32 m0, s54, 5376
    s_add_u32 s55, s83, 2924544
    buffer_load_dwordx4 v4, s[8:11], s55 offen  lds
    s_add_u32 m0, s54, 6272
    s_add_u32 s55, s83, 2938880
    buffer_load_dwordx4 v4, s[8:11], s55 offen  lds
    s_mov_b64 exec, -1
    s_cmp_eq_u32 s46, 0
    s_cselect_b64 s[62:63], -1, 0
    v_cndmask_b32 v18, v17, v15, s[62:63]
    s_add_u32 s55, s80, 0
    buffer_load_dword v16, v18, s[12:15], s55 offen
    s_lshl_b32 s86, s43, 4
    s_add_u32 s86, s86, s40
    s_mul_i32 s86, s86, 896
    s_add_u32 s86, s86, 65536
    s_and_b32 s87, s40, 7
    s_and_b32 s60, s2, 7
    s_lshl_b32 s60, s60, 1
    s_lshr_b32 s61, s2, 7
    s_add_u32 s60, s60, s61
    s_bfe_u32 s61, s2, 0x40003
    s_lshl_b32 s90, s60, 10
    s_lshl_b32 s91, s61, 6
    s_add_u32 s90, s90, s91
    s_lshl_b32 s95, s60, 20
    s_lshr_b32 s62, s61, 1
    s_lshl_b32 s62, s62, 10
    s_add_u32 s95, s95, s62
    s_and_b32 s62, s61, 1
    s_lshl_b32 s62, s62, 7
    s_add_u32 s95, s95, s62
    s_lshl_b32 s62, s46, 14
    s_add_u32 s95, s95, s62
    s_add_u32 s95, s95, 917504
    s_lshl_b32 s91, s60, 7
    s_lshl_b32 s61, s61, 2
    s_add_u32 s91, s91, s61
    s_add_u32 s91, s91, 737280
    s_lshl_b32 s92, s43, 7
    s_lshl_b32 s61, s40, 2
    s_add_u32 s92, s92, s61
    s_add_u32 s92, s92, 741376
    s_lshl_b32 s93, s2, 2
    s_add_u32 s93, s93, 745472
    v_cmp_gt_u32 vcc, 16, v1
    s_lshl_b32 s60, s40, 7
    s_add_u32 s60, s60, 737280
    s_lshl_b32 s61, s43, 7
    s_add_u32 s61, s61, 741376
    v_mov_b32 v62, s60
    v_mov_b32 v63, s61
    v_and_b32 v10, 15, v1
    v_cndmask_b32 v62, v63, v62, vcc
    v_lshl_add_u32 v62, v10, 2, v62
    s_waitcnt vmcnt(13) lgkmcnt(0)
    s_barrier
    s_add_u32 m0, s96, 45056
    s_add_u32 s55, s84, 896
    buffer_load_dwordx4 v2, s[4:7], s55 offen lds
    s_add_u32 m0, s96, 46080
    s_add_u32 s55, s84, 17280
    buffer_load_dwordx4 v2, s[4:7], s55 offen lds
    s_add_u32 m0, s96, 47104
    s_add_u32 s55, s84, 33664
    buffer_load_dwordx4 v2, s[4:7], s55 offen lds
    s_add_u32 m0, s96, 48128
    s_add_u32 s55, s84, 50048
    buffer_load_dwordx4 v2, s[4:7], s55 offen lds
    s_mov_b32 exec_hi, 0xffffff
    s_add_u32 m0, s54, 45056
    s_add_u32 s55, s83, 3211264
    buffer_load_dwordx4 v3, s[8:11], s55 offen  lds
    s_add_u32 m0, s54, 45952
    s_add_u32 s55, s83, 3225600
    buffer_load_dwordx4 v3, s[8:11], s55 offen  lds
    s_add_u32 m0, s54, 46848
    s_add_u32 s55, s83, 3268608
    buffer_load_dwordx4 v4, s[8:11], s55 offen  lds
    s_add_u32 m0, s54, 47744
    s_add_u32 s55, s83, 3282944
    buffer_load_dwordx4 v4, s[8:11], s55 offen  lds
    s_add_u32 m0, s54, 48640
    s_add_u32 s55, s83, 3325952
    buffer_load_dwordx4 v3, s[8:11], s55 offen  lds
    s_add_u32 m0, s54, 49536
    s_add_u32 s55, s83, 3340288
    buffer_load_dwordx4 v3, s[8:11], s55 offen  lds
    s_add_u32 m0, s54, 50432
    s_add_u32 s55, s83, 3383296
    buffer_load_dwordx4 v4, s[8:11], s55 offen  lds
    s_add_u32 m0, s54, 51328
    s_add_u32 s55, s83, 3397632
    buffer_load_dwordx4 v4, s[8:11], s55 offen  lds
    s_mov_b64 exec, -1
    s_waitcnt vmcnt(13) lgkmcnt(0)
    s_barrier
    s_add_u32 m0, s96, 90112
    s_add_u32 s55, s85, 1024
    buffer_load_dwordx4 v2, s[4:7], s55 offen lds
    s_add_u32 m0, s96, 91136
    s_add_u32 s55, s85, 17408
    buffer_load_dwordx4 v2, s[4:7], s55 offen lds
    s_add_u32 m0, s96, 92160
    s_add_u32 s55, s85, 33792
    buffer_load_dwordx4 v2, s[4:7], s55 offen lds
    s_add_u32 m0, s96, 93184
    s_add_u32 s55, s85, 50176
    buffer_load_dwordx4 v2, s[4:7], s55 offen lds
    s_mov_b32 exec_hi, 0xffffff
    s_add_u32 m0, s54, 90112
    s_sub_u32 s55, 3670016, s83
    buffer_load_dwordx4 v3, s[8:11], s55 offen  lds
    s_add_u32 m0, s54, 91008
    s_sub_u32 s55, 3684352, s83
    buffer_load_dwordx4 v3, s[8:11], s55 offen  lds
    s_add_u32 m0, s54, 91904
    s_sub_u32 s55, 3727360, s83
    buffer_load_dwordx4 v4, s[8:11], s55 offen  lds
    s_add_u32 m0, s54, 92800
    s_sub_u32 s55, 3741696, s83
    buffer_load_dwordx4 v4, s[8:11], s55 offen  lds
    s_add_u32 m0, s54, 93696
    s_sub_u32 s55, 3784704, s83
    buffer_load_dwordx4 v3, s[8:11], s55 offen  lds
    s_add_u32 m0, s54, 94592
    s_sub_u32 s55, 3799040, s83
    buffer_load_dwordx4 v3, s[8:11], s55 offen  lds
    s_add_u32 m0, s54, 95488
    s_sub_u32 s55, 3842048, s83
    buffer_load_dwordx4 v4, s[8:11], s55 offen  lds
    s_add_u32 m0, s54, 96384
    s_sub_u32 s55, 3856384, s83
    buffer_load_dwordx4 v4, s[8:11], s55 offen  lds
    s_mov_b64 exec, -1
    s_cmp_eq_u32 s46, 1
    s_cselect_b64 s[62:63], -1, 0
    v_cndmask_b32 v18, v17, v15, s[62:63]
    s_add_u32 s55, s80, 7168
    buffer_load_dword v16, v18, s[12:15], s55 offen
    v_and_b32 v10, 15, v1
    v_lshlrev_b32 v41, 6, v10
    v_bfe_u32 v10, v1, 4, 1
    v_lshl_add_u32 v41, v10, 5, v41
    v_lshrrev_b32 v11, 5, v1
    v_lshl_add_u32 v41, v11, 4, v41
    v_and_b32 v12, 7, v1
    v_bfe_u32 v10, v1, 3, 2
    v_lshlrev_b32 v43, 4, v12
    v_lshl_add_u32 v43, v11, 13, v43
    v_lshl_add_u32 v43, v10, 8, v43
    s_lshl_b32 s89, s46, 20
    s_lshl_b32 s60, s2, 11
    s_add_u32 s89, s89, s60
    s_add_u32 s88, s89, 4194304
    s_waitcnt vmcnt(13) lgkmcnt(0)
    s_barrier
    s_add_u32 m0, s96, 0
    s_add_u32 s55, s85, 1152
    buffer_load_dwordx4 v2, s[4:7], s55 offen lds
    s_add_u32 m0, s96, 1024
    s_add_u32 s55, s85, 17536
    buffer_load_dwordx4 v2, s[4:7], s55 offen lds
    s_add_u32 m0, s96, 2048
    s_add_u32 s55, s85, 33920
    buffer_load_dwordx4 v2, s[4:7], s55 offen lds
    s_add_u32 m0, s96, 3072
    s_add_u32 s55, s85, 50304
    buffer_load_dwordx4 v2, s[4:7], s55 offen lds
    s_mov_b32 exec_hi, 0xffffff
    s_add_u32 m0, s54, 0
    s_sub_u32 s55, 4128768, s83
    buffer_load_dwordx4 v3, s[8:11], s55 offen  lds
    s_add_u32 m0, s54, 896
    s_sub_u32 s55, 4143104, s83
    buffer_load_dwordx4 v3, s[8:11], s55 offen  lds
    s_add_u32 m0, s54, 1792
    s_sub_u32 s55, 4186112, s83
    buffer_load_dwordx4 v4, s[8:11], s55 offen  lds
    s_add_u32 m0, s54, 2688
    s_sub_u32 s55, 4200448, s83
    buffer_load_dwordx4 v4, s[8:11], s55 offen  lds
    s_add_u32 m0, s54, 3584
    s_sub_u32 s55, 4243456, s83
    buffer_load_dwordx4 v3, s[8:11], s55 offen  lds
    s_add_u32 m0, s54, 4480
    s_sub_u32 s55, 4257792, s83
    buffer_load_dwordx4 v3, s[8:11], s55 offen  lds
    s_add_u32 m0, s54, 5376
    s_sub_u32 s55, 4300800, s83
    buffer_load_dwordx4 v4, s[8:11], s55 offen  lds
    s_add_u32 m0, s54, 6272
    s_sub_u32 s55, 4315136, s83
    buffer_load_dwordx4 v4, s[8:11], s55 offen  lds
    s_mov_b64 exec, -1
    s_waitcnt vmcnt(13) lgkmcnt(0)
    s_barrier
    s_add_u32 m0, s96, 45056
    s_add_u32 s55, s85, 1280
    buffer_load_dwordx4 v2, s[4:7], s55 offen lds
    s_add_u32 m0, s96, 46080
    s_add_u32 s55, s85, 17664
    buffer_load_dwordx4 v2, s[4:7], s55 offen lds
    s_add_u32 m0, s96, 47104
    s_add_u32 s55, s85, 34048
    buffer_load_dwordx4 v2, s[4:7], s55 offen lds
    s_add_u32 m0, s96, 48128
    s_add_u32 s55, s85, 50432
    buffer_load_dwordx4 v2, s[4:7], s55 offen lds
    s_mov_b32 exec_hi, 0xffffff
    s_add_u32 m0, s54, 45056
    s_sub_u32 s55, 4587520, s83
    buffer_load_dwordx4 v3, s[8:11], s55 offen  lds
    s_add_u32 m0, s54, 45952
    s_sub_u32 s55, 4601856, s83
    buffer_load_dwordx4 v3, s[8:11], s55 offen  lds
    s_add_u32 m0, s54, 46848
    s_sub_u32 s55, 4644864, s83
    buffer_load_dwordx4 v4, s[8:11], s55 offen  lds
    s_add_u32 m0, s54, 47744
    s_sub_u32 s55, 4659200, s83
    buffer_load_dwordx4 v4, s[8:11], s55 offen  lds
    s_add_u32 m0, s54, 48640
    s_sub_u32 s55, 4702208, s83
    buffer_load_dwordx4 v3, s[8:11], s55 offen  lds
    s_add_u32 m0, s54, 49536
    s_sub_u32 s55, 4716544, s83
    buffer_load_dwordx4 v3, s[8:11], s55 offen  lds
    s_add_u32 m0, s54, 50432
    s_sub_u32 s55, 4759552, s83
    buffer_load_dwordx4 v4, s[8:11], s55 offen  lds
    s_add_u32 m0, s54, 51328
    s_sub_u32 s55, 4773888, s83
    buffer_load_dwordx4 v4, s[8:11], s55 offen  lds
    s_mov_b64 exec, -1
    s_cmp_eq_u32 s46, 2
    s_cselect_b64 s[62:63], -1, 0
    v_cndmask_b32 v18, v17, v15, s[62:63]
    s_add_u32 s55, s80, 14336
    buffer_load_dword v16, v18, s[12:15], s55 offen
    s_cmp_eq_u32 s46, 0
    s_cselect_b64 s[62:63], -1, 0
    v_cndmask_b32 v18, v17, v19, s[62:63]
    s_mov_b64 exec, 15
    buffer_store_dwordx4 v[48:51], v18, s[32:35], s90 offen offset:0 sc1
    s_mov_b64 exec, -1
    buffer_store_dwordx4 v[120:123], v43, s[24:27], s95 offen sc1
    s_add_u32 s95, s95, 65536
    buffer_store_dwordx4 v[124:127], v43, s[24:27], s95 offen sc1
    s_waitcnt vmcnt(16) lgkmcnt(0)
    s_barrier
    s_add_u32 m0, s96, 90112
    s_add_u32 s55, s85, 1408
    buffer_load_dwordx4 v2, s[4:7], s55 offen lds
    s_add_u32 m0, s96, 91136
    s_add_u32 s55, s85, 17792
    buffer_load_dwordx4 v2, s[4:7], s55 offen lds
    s_add_u32 m0, s96, 92160
    s_add_u32 s55, s85, 34176
    buffer_load_dwordx4 v2, s[4:7], s55 offen lds
    s_add_u32 m0, s96, 93184
    s_add_u32 s55, s85, 50560
    buffer_load_dwordx4 v2, s[4:7], s55 offen lds
    s_mov_b32 exec_hi, 0xffffff
    s_add_u32 m0, s54, 90112
    s_sub_u32 s55, 5046272, s83
    buffer_load_dwordx4 v3, s[8:11], s55 offen  lds
    s_add_u32 m0, s54, 91008
    s_sub_u32 s55, 5060608, s83
    buffer_load_dwordx4 v3, s[8:11], s55 offen  lds
    s_add_u32 m0, s54, 91904
    s_sub_u32 s55, 5103616, s83
    buffer_load_dwordx4 v4, s[8:11], s55 offen  lds
    s_add_u32 m0, s54, 92800
    s_sub_u32 s55, 5117952, s83
    buffer_load_dwordx4 v4, s[8:11], s55 offen  lds
    s_add_u32 m0, s54, 93696
    s_sub_u32 s55, 5160960, s83
    buffer_load_dwordx4 v3, s[8:11], s55 offen  lds
    s_add_u32 m0, s54, 94592
    s_sub_u32 s55, 5175296, s83
    buffer_load_dwordx4 v3, s[8:11], s55 offen  lds
    s_add_u32 m0, s54, 95488
    s_sub_u32 s55, 5218304, s83
    buffer_load_dwordx4 v4, s[8:11], s55 offen  lds
    s_add_u32 m0, s54, 96384
    s_sub_u32 s55, 5232640, s83
    buffer_load_dwordx4 v4, s[8:11], s55 offen  lds
    s_mov_b64 exec, -1
    v_add_u32 v11, 137216, v19
    ds_read_b128 v[28:31], v11
    s_cmp_eq_u32 s46, 1
    s_cselect_b64 s[62:63], -1, 0
    v_cndmask_b32 v18, v17, v19, s[62:63]
    s_waitcnt lgkmcnt(0)
    s_mov_b32 exec_hi, 0xffffff
    buffer_store_dwordx4 v[28:31], v18, s[32:35], s86 offen sc1
    s_mov_b64 exec, -1
    s_waitcnt vmcnt(17) lgkmcnt(0)
    s_barrier
    s_add_u32 m0, s96, 0
    s_add_u32 s55, s85, 1536
    buffer_load_dwordx4 v2, s[4:7], s55 offen lds
    s_add_u32 m0, s96, 1024
    s_add_u32 s55, s85, 17920
    buffer_load_dwordx4 v2, s[4:7], s55 offen lds
    s_add_u32 m0, s96, 2048
    s_add_u32 s55, s85, 34304
    buffer_load_dwordx4 v2, s[4:7], s55 offen lds
    s_add_u32 m0, s96, 3072
    s_add_u32 s55, s85, 50688
    buffer_load_dwordx4 v2, s[4:7], s55 offen lds
    s_mov_b32 exec_hi, 0xffffff
    s_add_u32 m0, s54, 0
    s_sub_u32 s55, 5505024, s83
    buffer_load_dwordx4 v3, s[8:11], s55 offen  lds
    s_add_u32 m0, s54, 896
    s_sub_u32 s55, 5519360, s83
    buffer_load_dwordx4 v3, s[8:11], s55 offen  lds
    s_add_u32 m0, s54, 1792
    s_sub_u32 s55, 5562368, s83
    buffer_load_dwordx4 v4, s[8:11], s55 offen  lds
    s_add_u32 m0, s54, 2688
    s_sub_u32 s55, 5576704, s83
    buffer_load_dwordx4 v4, s[8:11], s55 offen  lds
    s_add_u32 m0, s54, 3584
    s_sub_u32 s55, 5619712, s83
    buffer_load_dwordx4 v3, s[8:11], s55 offen  lds
    s_add_u32 m0, s54, 4480
    s_sub_u32 s55, 5634048, s83
    buffer_load_dwordx4 v3, s[8:11], s55 offen  lds
    s_add_u32 m0, s54, 5376
    s_sub_u32 s55, 5677056, s83
    buffer_load_dwordx4 v4, s[8:11], s55 offen  lds
    s_add_u32 m0, s54, 6272
    s_sub_u32 s55, 5691392, s83
    buffer_load_dwordx4 v4, s[8:11], s55 offen  lds
    s_mov_b64 exec, -1
    s_cmp_eq_u32 s46, 3
    s_cselect_b64 s[62:63], -1, 0
    v_cndmask_b32 v18, v17, v15, s[62:63]
    s_add_u32 s55, s80, 21504
    buffer_load_dword v16, v18, s[12:15], s55 offen
    s_waitcnt vmcnt(14) lgkmcnt(0)
    s_barrier
    s_add_u32 m0, s96, 45056
    s_add_u32 s55, s85, 1664
    buffer_load_dwordx4 v2, s[4:7], s55 offen lds
    s_add_u32 m0, s96, 46080
    s_add_u32 s55, s85, 18048
    buffer_load_dwordx4 v2, s[4:7], s55 offen lds
    s_add_u32 m0, s96, 47104
    s_add_u32 s55, s85, 34432
    buffer_load_dwordx4 v2, s[4:7], s55 offen lds
    s_add_u32 m0, s96, 48128
    s_add_u32 s55, s85, 50816
    buffer_load_dwordx4 v2, s[4:7], s55 offen lds
    s_mov_b32 exec_hi, 0xffffff
    s_add_u32 m0, s54, 45056
    s_sub_u32 s55, 5963776, s83
    buffer_load_dwordx4 v3, s[8:11], s55 offen  lds
    s_add_u32 m0, s54, 45952
    s_sub_u32 s55, 5978112, s83
    buffer_load_dwordx4 v3, s[8:11], s55 offen  lds
    s_add_u32 m0, s54, 46848
    s_sub_u32 s55, 6021120, s83
    buffer_load_dwordx4 v4, s[8:11], s55 offen  lds
    s_add_u32 m0, s54, 47744
    s_sub_u32 s55, 6035456, s83
    buffer_load_dwordx4 v4, s[8:11], s55 offen  lds
    s_add_u32 m0, s54, 48640
    s_sub_u32 s55, 6078464, s83
    buffer_load_dwordx4 v3, s[8:11], s55 offen  lds
    s_add_u32 m0, s54, 49536
    s_sub_u32 s55, 6092800, s83
    buffer_load_dwordx4 v3, s[8:11], s55 offen  lds
    s_add_u32 m0, s54, 50432
    s_sub_u32 s55, 6135808, s83
    buffer_load_dwordx4 v4, s[8:11], s55 offen  lds
    s_add_u32 m0, s54, 51328
    s_sub_u32 s55, 6150144, s83
    buffer_load_dwordx4 v4, s[8:11], s55 offen  lds
    s_mov_b64 exec, -1
    s_cmp_lg_u32 s46, 2
    s_cbranch_scc1 ct_5
    s_getpc_b64 s[60:61]
pc_6:
    s_sub_u32 s60, s60, pc_6-recurrent_scan__spectral_fnet__dense_activation_silu__prompt_kernel
    s_subb_u32 s61, s61, 0
    s_lshr_b32 s62, s2, 3
    s_lshl_b32 s62, s62, 11
    v_lshlrev_b32 v10, 7, v1
    v_add_u32 v10, s62, v10
    v_min_u32 v10, L_end-recurrent_scan__spectral_fnet__dense_activation_silu__prompt_kernel, v10
    s_mov_b64 exec, 0xffff
    global_load_dword v16, v10, s[60:61]
    s_mov_b64 exec, -1
ct_5:
    s_waitcnt vmcnt(13) lgkmcnt(0)
    s_barrier
    s_cmp_eq_u32 s46, 0
    s_cselect_b64 s[62:63], -1, 0
    v_cndmask_b32 v18, v17, v58, s[62:63]
    s_mov_b64 exec, 1
    buffer_store_dword v60, v18, s[32:35], s91 offen sc1
    buffer_store_dword v60, v18, s[32:35], s92 offen sc1
    s_mov_b64 exec, -1
    s_add_u32 m0, s96, 90112
    s_add_u32 s55, s85, 1792
    buffer_load_dwordx4 v2, s[4:7], s55 offen lds
    s_add_u32 m0, s96, 91136
    s_add_u32 s55, s85, 18176
    buffer_load_dwordx4 v2, s[4:7], s55 offen lds
    s_add_u32 m0, s96, 92160
    s_add_u32 s55, s85, 34560
    buffer_load_dwordx4 v2, s[4:7], s55 offen lds
    s_add_u32 m0, s96, 93184
    s_add_u32 s55, s85, 50944
    buffer_load_dwordx4 v2, s[4:7], s55 offen lds
    s_mov_b32 exec_hi, 0xffffff
    s_add_u32 m0, s54, 90112
    s_sub_u32 s55, 6422528, s83
    buffer_load_dwordx4 v3, s[8:11], s55 offen  lds
    s_add_u32 m0, s54, 91008
    s_sub_u32 s55, 6436864, s83
    buffer_load_dwordx4 v3, s[8:11], s55 offen  lds
    s_add_u32 m0, s54, 91904
    s_sub_u32 s55, 6479872, s83
    buffer_load_dwordx4 v4, s[8:11], s55 offen  lds
    s_add_u32 m0, s54, 92800
    s_sub_u32 s55, 6494208, s83
    buffer_load_dwordx4 v4, s[8:11], s55 offen  lds
    s_add_u32 m0, s54, 93696
    s_sub_u32 s55, 6537216, s83
    buffer_load_dwordx4 v3, s[8:11], s55 offen  lds
    s_add_u32 m0, s54, 94592
    s_sub_u32 s55, 6551552, s83
    buffer_load_dwordx4 v3, s[8:11], s55 offen  lds
    s_add_u32 m0, s54, 95488
    s_sub_u32 s55, 6594560, s83
    buffer_load_dwordx4 v4, s[8:11], s55 offen  lds
    s_add_u32 m0, s54, 96384
    s_sub_u32 s55, 6608896, s83
    buffer_load_dwordx4 v4, s[8:11], s55 offen  lds
    s_mov_b64 exec, -1
    s_waitcnt vmcnt(14) lgkmcnt(0)
    s_barrier
    s_add_u32 m0, s96, 0
    s_add_u32 s55, s85, 1920
    buffer_load_dwordx4 v2, s[4:7], s55 offen lds
    s_add_u32 m0, s96, 1024
    s_add_u32 s55, s85, 18304
    buffer_load_dwordx4 v2, s[4:7], s55 offen lds
    s_add_u32 m0, s96, 2048
    s_add_u32 s55, s85, 34688
    buffer_load_dwordx4 v2, s[4:7], s55 offen lds
    s_add_u32 m0, s96, 3072
    s_add_u32 s55, s85, 51072
    buffer_load_dwordx4 v2, s[4:7], s55 offen lds
    s_mov_b32 exec_hi, 0xffffff
    s_add_u32 m0, s54, 0
    s_sub_u32 s55, 6881280, s83
    buffer_load_dwordx4 v3, s[8:11], s55 offen  lds
    s_add_u32 m0, s54, 896
    s_sub_u32 s55, 6895616, s83
    buffer_load_dwordx4 v3, s[8:11], s55 offen  lds
    s_add_u32 m0, s54, 1792
    s_sub_u32 s55, 6938624, s83
    buffer_load_dwordx4 v4, s[8:11], s55 offen  lds
    s_add_u32 m0, s54, 2688
    s_sub_u32 s55, 6952960, s83
    buffer_load_dwordx4 v4, s[8:11], s55 offen  lds
    s_add_u32 m0, s54, 3584
    s_sub_u32 s55, 6995968, s83
    buffer_load_dwordx4 v3, s[8:11], s55 offen  lds
    s_add_u32 m0, s54, 4480
    s_sub_u32 s55, 7010304, s83
    buffer_load_dwordx4 v3, s[8:11], s55 offen  lds
    s_add_u32 m0, s54, 5376
    s_sub_u32 s55, 7053312, s83
    buffer_load_dwordx4 v4, s[8:11], s55 offen  lds
    s_add_u32 m0, s54, 6272
    s_sub_u32 s55, 7067648, s83
    buffer_load_dwordx4 v4, s[8:11], s55 offen  lds
    s_mov_b64 exec, -1
    buffer_load_dword v63, v62, s[32:35], 0 offen sc1
    s_waitcnt vmcnt(13) lgkmcnt(0)
    s_barrier
    s_waitcnt vmcnt(0)
    s_mov_b32 s73, 0
    v_cmp_ne_u32 vcc, s94, v63
    s_nop 1
    s_cmp_eq_u64 vcc, 0
    s_cbranch_scc1 pp_done_8
pp_spin_7:
    buffer_load_dword v63, v62, s[32:35], 0 offen sc1
    s_waitcnt vmcnt(0)
    v_cmp_ne_u32 vcc, s94, v63
    s_nop 1
    s_cmp_eq_u64 vcc, 0
    s_cbranch_scc1 pp_done_8
    s_sleep 1
    s_add_u32 s73, s73, 1
    s_cmp_lt_u32 s73, 0x8000
    s_cbranch_scc1 pp_spin_7
pp_done_8:
    s_lshl_b32 s60, s40, 10
    s_lshl_b32 s61, s46, 8
    s_add_u32 s60, s60, s61
    s_add_u32 m0, s61, 135168
    v_lshlrev_b32 v10, 2, v1
    buffer_load_dword v10, s[32:35], s60 offen sc1 lds
    v_lshrrev_b32 v10, 4, v1
    v_mul_u32_u24 v10, 3584, v10
    v_and_b32 v11, 15, v1
    v_lshl_add_u32 v10, v11, 4, v10
    s_mul_i32 s60, s43, 14336
    s_mul_i32 s61, s46, 224
    s_add_u32 s60, s60, s61
    s_add_u32 s60, s60, 65536
    buffer_load_dwordx4 v[20:23], v10, s[32:35], s60 offen offset:0 sc1
    buffer_load_dwordx4 v[24:27], v10, s[32:35], s60 offen offset:896 sc1
    buffer_load_dwordx4 v[28:31], v10, s[32:35], s60 offen offset:1792 sc1
    buffer_load_dwordx4 v[32:35], v10, s[32:35], s60 offen offset:2688 sc1
    s_add_u32 s61, s61, 136192
    v_lshlrev_b32 v11, 4, v11
    v_add_u32 v11, s61, v11
    s_waitcnt vmcnt(6) lgkmcnt(0)
    s_barrier
    s_waitcnt vmcnt(0)
    v_pk_add_f32 v[20:21], v[20:21], v[24:25]
    v_pk_add_f32 v[22:23], v[22:23], v[26:27]
    v_pk_add_f32 v[20:21], v[20:21], v[28:29]
    v_pk_add_f32 v[22:23], v[22:23], v[30:31]
    v_pk_add_f32 v[20:21], v[20:21], v[32:33]
    v_pk_add_f32 v[22:23], v[22:23], v[34:35]
    v_mov_b32 v24, v20
    v_mov_b32 v25, v21
    v_mov_b32 v26, v22
    v_mov_b32 v27, v23
    v_permlane16_swap_b32 v24, v20
    v_permlane16_swap_b32 v25, v21
    v_permlane16_swap_b32 v26, v22
    v_permlane16_swap_b32 v27, v23
    v_pk_add_f32 v[20:21], v[20:21], v[24:25]
    v_pk_add_f32 v[22:23], v[22:23], v[26:27]
    v_mov_b32 v24, v20
    v_mov_b32 v25, v21
    v_mov_b32 v26, v22
    v_mov_b32 v27, v23
    v_permlane32_swap_b32 v24, v20
    v_permlane32_swap_b32 v25, v21
    v_permlane32_swap_b32 v26, v22
    v_permlane32_swap_b32 v27, v23
    v_pk_add_f32 v[20:21], v[20:21], v[24:25]
    v_pk_add_f32 v[22:23], v[22:23], v[26:27]
    v_mov_b32 v57, 141376
    s_mov_b64 exec, 0x3fff
    ds_write_b128 v11, v[20:23]
    ds_write_b32 v57, v60
    s_mov_b64 exec, -1
    s_waitcnt lgkmcnt(0)
    s_barrier
    v_add_u32 v5, s96, v240
    v_lshrrev_b32 v10, 4, v1
    v_and_b32 v11, 15, v1
    v_lshlrev_b32 v12, 1, v10
    v_xor_b32 v13, v11, v12
    v_lshlrev_b32 v6, 11, v10
    v_lshl_add_u32 v7, v13, 4, v6
    v_xor_b32 v13, 8, v13
    v_lshl_add_u32 v8, v13, 4, v6
    v_add_u32 v8, 8192, v8
    s_lshl_b32 s60, s46, 15
    s_lshl_b32 s61, s42, 8
    s_add_u32 s60, s60, s61
    v_add_u32 v6, s60, v7
    v_add_u32 v7, s60, v8
    s_lshl_b32 s60, s100, 13
    v_subrev_u32 v5, s60, v5
    s_lshl_b32 s60, s100, 16
    v_subrev_u32 v8, s60, v6
    v_subrev_u32 v9, s60, v7
    s_add_u32 s84, s96, 16384
    s_lshl_b32 s87, s40, 20
    s_mul_i32 s82, s41, 458752
    s_add_u32 s82, s82, s87
    s_mul_i32 s83, s41, 3670016
    s_mul_i32 s99, s42, 7
    s_mov_b32 s89, s100
    s_add_u32 s90, s100, 6
    s_sub_u32 s92, s89, 7
    s_cmp_ge_u32 s92, s99
    s_cselect_b32 s98, 7, 0
    s_add_u32 s92, s92, s98
    s_add_u32 s98, s89, s99
    s_cmp_lt_u32 s89, 7
    s_cselect_b32 s91, s98, s92
    s_add_u32 s89, s89, 2
    s_lshl_b32 s91, s91, 16
    s_add_u32 s91, s91, s83
    s_add_u32 s55, s91, 16384
    s_add_u32 m0, s84, 0
    s_nop 0
    buffer_load_dwordx4 v8, s[12:15], s91 offen  lds
    s_add_u32 m0, s84, 1024
    s_nop 0
    buffer_load_dwordx4 v9, s[12:15], s91 offen  lds
    s_add_u32 m0, s84, 2048
    s_nop 0
    buffer_load_dwordx4 v8, s[12:15], s55 offen  lds
    s_add_u32 m0, s84, 3072
    s_nop 0
    buffer_load_dwordx4 v9, s[12:15], s55 offen  lds
    s_sub_u32 s92, s89, 7
    s_cmp_ge_u32 s92, s99
    s_cselect_b32 s98, 7, 0
    s_add_u32 s92, s92, s98
    s_add_u32 s98, s89, s99
    s_cmp_lt_u32 s89, 7
    s_cselect_b32 s91, s98, s92
    s_add_u32 s89, s89, 2
    s_lshl_b32 s91, s91, 16
    s_add_u32 s91, s91, s83
    s_add_u32 s55, s91, 16384
    s_add_u32 m0, s84, 32768
    s_nop 0
    buffer_load_dwordx4 v8, s[12:15], s91 offen  lds
    s_add_u32 m0, s84, 33792
    s_nop 0
    buffer_load_dwordx4 v9, s[12:15], s91 offen  lds
    s_add_u32 m0, s84, 34816
    s_nop 0
    buffer_load_dwordx4 v8, s[12:15], s55 offen  lds
    s_add_u32 m0, s84, 35840
    s_nop 0
    buffer_load_dwordx4 v9, s[12:15], s55 offen  lds
    s_sub_u32 s92, s89, 7
    s_cmp_ge_u32 s92, s99
    s_cselect_b32 s98, 7, 0
    s_add_u32 s92, s92, s98
    s_add_u32 s98, s89, s99
    s_cmp_lt_u32 s89, 7
    s_cselect_b32 s91, s98, s92
    s_add_u32 s89, s89, 2
    s_lshl_b32 s91, s91, 16
    s_add_u32 s91, s91, s83
    s_add_u32 s55, s91, 16384
    s_add_u32 m0, s84, 65536
    s_nop 0
    buffer_load_dwordx4 v8, s[12:15], s91 offen  lds
    s_add_u32 m0, s84, 66560
    s_nop 0
    buffer_load_dwordx4 v9, s[12:15], s91 offen  lds
    s_add_u32 m0, s84, 67584
    s_nop 0
    buffer_load_dwordx4 v8, s[12:15], s55 offen  lds
    s_add_u32 m0, s84, 68608
    s_nop 0
    buffer_load_dwordx4 v9, s[12:15], s55 offen  lds
    s_sub_u32 s92, s89, 7
    s_cmp_ge_u32 s92, s99
    s_cselect_b32 s98, 7, 0
    s_add_u32 s92, s92, s98
    s_add_u32 s98, s89, s99
    s_cmp_lt_u32 s89, 7
    s_cselect_b32 s91, s98, s92
    s_add_u32 s89, s89, 2
    s_lshl_b32 s91, s91, 16
    s_add_u32 s91, s91, s83
    s_add_u32 s55, s91, 16384
    s_add_u32 m0, s84, 98304
    s_nop 0
    buffer_load_dwordx4 v8, s[12:15], s91 offen  lds
    s_add_u32 m0, s84, 99328
    s_nop 0
    buffer_load_dwordx4 v9, s[12:15], s91 offen  lds
    s_add_u32 m0, s84, 100352
    s_nop 0
    buffer_load_dwordx4 v8, s[12:15], s55 offen  lds
    s_add_u32 m0, s84, 101376
    s_nop 0
    buffer_load_dwordx4 v9, s[12:15], s55 offen  lds
    s_lshl_b32 s85, s100, 13
    s_lshl_b32 s60, s101, 12
    s_add_u32 s85, s85, s60
    s_lshl_b32 s60, s41, 11
    s_add_u32 s85, s85, s60
    s_add_u32 s87, s87, s85
    s_add_u32 s87, s87, 917504
    s_lshl_b32 s88, s44, 20
    v_and_b32 v10, 3, v1
    v_lshrrev_b32 v14, 2, v1
    v_and_b32 v14, 7, v14
    v_lshlrev_b32 v14, 5, v14
    v_lshl_add_u32 v14, v10, 2, v14
    s_cmp_eq_u32 s46, 0
    s_cselect_b64 s[62:63], -1, 0
    v_cndmask_b32 v16, v17, v58, s[62:63]
    s_mov_b32 s97, 745472
    s_cmp_eq_u32 s42, 0
    s_cselect_b32 s81, 0xf0, 15
    v_lshrrev_b32 v12, 5, v1
    v_lshlrev_b32 v12, 8, v12
    v_bfe_u32 v10, v1, 2, 2
    v_lshl_add_u32 v12, v10, 6, v12
    v_bfe_u32 v10, v1, 4, 1
    v_lshl_add_u32 v12, v10, 5, v12
    v_and_b32 v10, 3, v1
    v_lshl_add_u32 v12, v10, 3, v12
    s_lshl_b32 s58, s46, 12
    s_add_u32 s58, s58, 141568
    v_add_u32 v13, s58, v12
    s_lshl_b32 s59, s2, 11
    s_lshl_b32 s48, s46, 20
    s_add_u32 s48, s48, s59
    s_add_u32 s49, s48, 524288
    s_sub_u32 s50, 8, s46
    s_cmp_eq_u32 s46, 0
    s_cselect_b32 s56, 0, -1
    s_cselect_b32 s58, 143616, s58
    s_cselect_b32 s57, 0, 0x80008000
    s_cselect_b32 s50, 4, s50
    s_lshl_b32 s50, s50, 20
    s_add_u32 s50, s50, s59
    s_add_u32 s51, s50, 524288
    v_add_u32 v12, s58, v12
    s_barrier
    s_waitcnt vmcnt(0)
    s_barrier
    ds_read_b64_tr_b16 v[216:217], v13 offset:0
    ds_read_b64_tr_b16 v[218:219], v13 offset:512
    ds_read_b64_tr_b16 v[220:221], v13 offset:1024
    ds_read_b64_tr_b16 v[222:223], v13 offset:1536
    ds_read_b64_tr_b16 v[224:225], v13 offset:2048
    ds_read_b64_tr_b16 v[226:227], v13 offset:2560
    ds_read_b64_tr_b16 v[228:229], v13 offset:3072
    ds_read_b64_tr_b16 v[230:231], v13 offset:3584
    ds_read_b64_tr_b16 v[96:97], v12 offset:0
    ds_read_b64_tr_b16 v[98:99], v12 offset:512
    ds_read_b64_tr_b16 v[100:101], v12 offset:1024
    ds_read_b64_tr_b16 v[102:103], v12 offset:1536
    ds_read_b64_tr_b16 v[104:105], v12 offset:2048
    ds_read_b64_tr_b16 v[106:107], v12 offset:2560
    ds_read_b64_tr_b16 v[108:109], v12 offset:3072
    ds_read_b64_tr_b16 v[110:111], v12 offset:3584
    s_waitcnt lgkmcnt(8)
    v_and_b32 v224, s56, v224
    v_and_b32 v225, s56, v225
    v_and_b32 v226, s56, v226
    v_and_b32 v227, s56, v227
    v_and_b32 v228, s56, v228
    v_and_b32 v229, s56, v229
    v_and_b32 v230, s56, v230
    v_and_b32 v231, s56, v231
    s_waitcnt lgkmcnt(0)
    v_mfma_f32_32x32x16_f16 v[184:199], v[216:219], v[160:163], 0
    v_and_b32 v104, s56, v104
    v_xor_b32 v104, s57, v104
    v_mfma_f32_32x32x16_f16 v[200:215], v[216:219], v[176:179], 0
    v_and_b32 v105, s56, v105
    v_xor_b32 v105, s57, v105
    v_mfma_f32_32x32x16_f16 v[184:199], v[220:223], v[164:167], v[184:199]
    v_and_b32 v106, s56, v106
    v_xor_b32 v106, s57, v106
    v_mfma_f32_32x32x16_f16 v[200:215], v[220:223], v[180:183], v[200:215]
    v_and_b32 v107, s56, v107
    v_xor_b32 v107, s57, v107
    v_mfma_f32_32x32x16_f16 v[184:199], v[224:227], v[168:171], v[184:199]
    v_and_b32 v108, s56, v108
    v_xor_b32 v108, s57, v108
    v_mfma_f32_32x32x16_f16 v[200:215], v[224:227], v[160:163], v[200:215]
    v_and_b32 v109, s56, v109
    v_xor_b32 v109, s57, v109
    v_mfma_f32_32x32x16_f16 v[184:199], v[228:231], v[172:175], v[184:199]
    v_and_b32 v110, s56, v110
    v_xor_b32 v110, s57, v110
    v_mfma_f32_32x32x16_f16 v[200:215], v[228:231], v[164:167], v[200:215]
    v_and_b32 v111, s56, v111
    v_xor_b32 v111, s57, v111
    v_mfma_f32_32x32x16_f16 v[64:79], v[96:99], v[160:163], 0
    v_mfma_f32_32x32x16_f16 v[80:95], v[96:99], v[176:179], 0
    v_mfma_f32_32x32x16_f16 v[64:79], v[100:103], v[164:167], v[64:79]
    v_mfma_f32_32x32x16_f16 v[80:95], v[100:103], v[180:183], v[80:95]
    s_nop 4
    v_mfma_f32_32x32x16_f16 v[64:79], v[104:107], v[168:171], v[64:79]
    v_pk_mul_f32 v[232:233], v[184:185], v[128:129]
    v_pk_mul_f32 v[234:235], v[200:201], v[128:129]
    v_pk_fma_f32 v[232:233], v[200:201], v[144:145], v[232:233]
    v_pk_fma_f32 v[234:235], v[184:185], v[144:145], v[234:235] neg_lo:[1,0,0] neg_hi:[1,0,0]
    v_cvt_pk_f16_f32 v216, v232, v233
    v_cvt_pk_f16_f32 v224, v234, v235
    v_mfma_f32_32x32x16_f16 v[80:95], v[104:107], v[160:163], v[80:95]
    v_pk_mul_f32 v[236:237], v[186:187], v[130:131]
    v_pk_mul_f32 v[238:239], v[202:203], v[130:131]
    v_pk_fma_f32 v[236:237], v[202:203], v[146:147], v[236:237]
    v_pk_fma_f32 v[238:239], v[186:187], v[146:147], v[238:239] neg_lo:[1,0,0] neg_hi:[1,0,0]
    v_cvt_pk_f16_f32 v217, v236, v237
    v_cvt_pk_f16_f32 v225, v238, v239
    v_mfma_f32_32x32x16_f16 v[64:79], v[108:111], v[172:175], v[64:79]
    v_pk_mul_f32 v[232:233], v[188:189], v[132:133]
    v_pk_mul_f32 v[234:235], v[204:205], v[132:133]
    v_pk_fma_f32 v[232:233], v[204:205], v[148:149], v[232:233]
    v_pk_fma_f32 v[234:235], v[188:189], v[148:149], v[234:235] neg_lo:[1,0,0] neg_hi:[1,0,0]
    v_cvt_pk_f16_f32 v218, v232, v233
    v_cvt_pk_f16_f32 v226, v234, v235
    v_mfma_f32_32x32x16_f16 v[80:95], v[108:111], v[164:167], v[80:95]
    v_pk_mul_f32 v[236:237], v[190:191], v[134:135]
    v_pk_mul_f32 v[238:239], v[206:207], v[134:135]
    v_pk_fma_f32 v[236:237], v[206:207], v[150:151], v[236:237]
    v_pk_fma_f32 v[238:239], v[190:191], v[150:151], v[238:239] neg_lo:[1,0,0] neg_hi:[1,0,0]
    v_cvt_pk_f16_f32 v219, v236, v237
    v_cvt_pk_f16_f32 v227, v238, v239
    v_pk_mul_f32 v[232:233], v[192:193], v[136:137]
    v_pk_mul_f32 v[234:235], v[208:209], v[136:137]
    v_pk_fma_f32 v[232:233], v[208:209], v[152:153], v[232:233]
    v_pk_fma_f32 v[234:235], v[192:193], v[152:153], v[234:235] neg_lo:[1,0,0] neg_hi:[1,0,0]
    v_cvt_pk_f16_f32 v220, v232, v233
    v_cvt_pk_f16_f32 v228, v234, v235
    v_pk_mul_f32 v[236:237], v[194:195], v[138:139]
    v_pk_mul_f32 v[238:239], v[210:211], v[138:139]
    v_pk_fma_f32 v[236:237], v[210:211], v[154:155], v[236:237]
    v_pk_fma_f32 v[238:239], v[194:195], v[154:155], v[238:239] neg_lo:[1,0,0] neg_hi:[1,0,0]
    v_cvt_pk_f16_f32 v221, v236, v237
    v_cvt_pk_f16_f32 v229, v238, v239
    v_pk_mul_f32 v[232:233], v[196:197], v[140:141]
    v_pk_mul_f32 v[234:235], v[212:213], v[140:141]
    v_pk_fma_f32 v[232:233], v[212:213], v[156:157], v[232:233]
    v_pk_fma_f32 v[234:235], v[196:197], v[156:157], v[234:235] neg_lo:[1,0,0] neg_hi:[1,0,0]
    v_cvt_pk_f16_f32 v222, v232, v233
    v_cvt_pk_f16_f32 v230, v234, v235
    v_pk_mul_f32 v[236:237], v[198:199], v[142:143]
    v_pk_mul_f32 v[238:239], v[214:215], v[142:143]
    v_pk_fma_f32 v[236:237], v[214:215], v[158:159], v[236:237]
    v_pk_fma_f32 v[238:239], v[198:199], v[158:159], v[238:239] neg_lo:[1,0,0] neg_hi:[1,0,0]
    v_cvt_pk_f16_f32 v223, v236, v237
    v_cvt_pk_f16_f32 v231, v238, v239
    s_nop 1
    v_mfma_f32_32x32x16_f16 v[184:199], v[216:219], v[160:163], 0
    v_pk_mul_f32 v[112:113], v[64:65], v[128:129]
    v_pk_mul_f32 v[114:115], v[80:81], v[128:129]
    v_pk_fma_f32 v[112:113], v[80:81], v[144:145], v[112:113]
    v_pk_fma_f32 v[114:115], v[64:65], v[144:145], v[114:115] neg_lo:[1,0,0] neg_hi:[1,0,0]
    v_cvt_pk_f16_f32 v96, v112, v113
    v_cvt_pk_f16_f32 v104, v114, v115
    v_mfma_f32_32x32x16_f16 v[200:215], v[216:219], v[176:179], 0
    v_pk_mul_f32 v[116:117], v[66:67], v[130:131]
    v_pk_mul_f32 v[118:119], v[82:83], v[130:131]
    v_pk_fma_f32 v[116:117], v[82:83], v[146:147], v[116:117]
    v_pk_fma_f32 v[118:119], v[66:67], v[146:147], v[118:119] neg_lo:[1,0,0] neg_hi:[1,0,0]
    v_cvt_pk_f16_f32 v97, v116, v117
    v_cvt_pk_f16_f32 v105, v118, v119
    v_mfma_f32_32x32x16_f16 v[184:199], v[220:223], v[164:167], v[184:199]
    v_pk_mul_f32 v[112:113], v[68:69], v[132:133]
    v_pk_mul_f32 v[114:115], v[84:85], v[132:133]
    v_pk_fma_f32 v[112:113], v[84:85], v[148:149], v[112:113]
    v_pk_fma_f32 v[114:115], v[68:69], v[148:149], v[114:115] neg_lo:[1,0,0] neg_hi:[1,0,0]
    v_cvt_pk_f16_f32 v98, v112, v113
    v_cvt_pk_f16_f32 v106, v114, v115
    v_mfma_f32_32x32x16_f16 v[200:215], v[220:223], v[180:183], v[200:215]
    v_pk_mul_f32 v[116:117], v[70:71], v[134:135]
    v_pk_mul_f32 v[118:119], v[86:87], v[134:135]
    v_pk_fma_f32 v[116:117], v[86:87], v[150:151], v[116:117]
    v_pk_fma_f32 v[118:119], v[70:71], v[150:151], v[118:119] neg_lo:[1,0,0] neg_hi:[1,0,0]
    v_cvt_pk_f16_f32 v99, v116, v117
    v_cvt_pk_f16_f32 v107, v118, v119
    v_mfma_f32_32x32x16_f16 v[184:199], v[224:227], v[168:171], v[184:199]
    v_pk_mul_f32 v[112:113], v[72:73], v[136:137]
    v_pk_mul_f32 v[114:115], v[88:89], v[136:137]
    v_pk_fma_f32 v[112:113], v[88:89], v[152:153], v[112:113]
    v_pk_fma_f32 v[114:115], v[72:73], v[152:153], v[114:115] neg_lo:[1,0,0] neg_hi:[1,0,0]
    v_cvt_pk_f16_f32 v100, v112, v113
    v_cvt_pk_f16_f32 v108, v114, v115
    v_mfma_f32_32x32x16_f16 v[200:215], v[224:227], v[160:163], v[200:215]
    v_pk_mul_f32 v[116:117], v[74:75], v[138:139]
    v_pk_mul_f32 v[118:119], v[90:91], v[138:139]
    v_pk_fma_f32 v[116:117], v[90:91], v[154:155], v[116:117]
    v_pk_fma_f32 v[118:119], v[74:75], v[154:155], v[118:119] neg_lo:[1,0,0] neg_hi:[1,0,0]
    v_cvt_pk_f16_f32 v101, v116, v117
    v_cvt_pk_f16_f32 v109, v118, v119
    v_mfma_f32_32x32x16_f16 v[184:199], v[228:231], v[172:175], v[184:199]
    v_pk_mul_f32 v[112:113], v[76:77], v[140:141]
    v_pk_mul_f32 v[114:115], v[92:93], v[140:141]
    v_pk_fma_f32 v[112:113], v[92:93], v[156:157], v[112:113]
    v_pk_fma_f32 v[114:115], v[76:77], v[156:157], v[114:115] neg_lo:[1,0,0] neg_hi:[1,0,0]
    v_cvt_pk_f16_f32 v102, v112, v113
    v_cvt_pk_f16_f32 v110, v114, v115
    v_mfma_f32_32x32x16_f16 v[200:215], v[228:231], v[164:167], v[200:215]
    v_pk_mul_f32 v[116:117], v[78:79], v[142:143]
    v_pk_mul_f32 v[118:119], v[94:95], v[142:143]
    v_pk_fma_f32 v[116:117], v[94:95], v[158:159], v[116:117]
    v_pk_fma_f32 v[118:119], v[78:79], v[158:159], v[118:119] neg_lo:[1,0,0] neg_hi:[1,0,0]
    v_cvt_pk_f16_f32 v103, v116, v117
    v_cvt_pk_f16_f32 v111, v118, v119
    s_nop 1
    v_mfma_f32_32x32x16_f16 v[64:79], v[96:99], v[160:163], 0
    v_mfma_f32_32x32x16_f16 v[80:95], v[96:99], v[176:179], 0
    v_mfma_f32_32x32x16_f16 v[64:79], v[100:103], v[164:167], v[64:79]
    v_mfma_f32_32x32x16_f16 v[80:95], v[100:103], v[180:183], v[80:95]
    v_mfma_f32_32x32x16_f16 v[64:79], v[104:107], v[168:171], v[64:79]
    v_cvt_pk_bf16_f32 v216, v184, v185
    v_cvt_pk_bf16_f32 v224, -v200, -v201
    v_cvt_pk_bf16_f32 v217, v186, v187
    v_cvt_pk_bf16_f32 v225, -v202, -v203
    v_cvt_pk_bf16_f32 v218, v188, v189
    v_cvt_pk_bf16_f32 v226, -v204, -v205
    v_cvt_pk_bf16_f32 v219, v190, v191
    v_cvt_pk_bf16_f32 v227, -v206, -v207
    v_mfma_f32_32x32x16_f16 v[80:95], v[104:107], v[160:163], v[80:95]
    v_cvt_pk_bf16_f32 v220, v192, v193
    v_cvt_pk_bf16_f32 v228, -v208, -v209
    v_cvt_pk_bf16_f32 v221, v194, v195
    v_cvt_pk_bf16_f32 v229, -v210, -v211
    v_cvt_pk_bf16_f32 v222, v196, v197
    v_cvt_pk_bf16_f32 v230, -v212, -v213
    v_cvt_pk_bf16_f32 v223, v198, v199
    v_cvt_pk_bf16_f32 v231, -v214, -v215
    v_mfma_f32_32x32x16_f16 v[64:79], v[108:111], v[172:175], v[64:79]
    s_nop 1
    v_permlane32_swap_b32 v216, v218
    v_permlane32_swap_b32 v217, v219
    v_permlane32_swap_b32 v220, v222
    v_permlane32_swap_b32 v221, v223
    v_permlane32_swap_b32 v224, v226
    v_permlane32_swap_b32 v225, v227
    v_permlane32_swap_b32 v228, v230
    v_mfma_f32_32x32x16_f16 v[80:95], v[108:111], v[164:167], v[80:95]
    v_permlane32_swap_b32 v229, v231
    s_nop 0
    v_permlane16_swap_b32 v216, v220
    v_permlane16_swap_b32 v217, v221
    v_permlane16_swap_b32 v218, v222
    v_permlane16_swap_b32 v219, v223
    v_permlane16_swap_b32 v224, v228
    v_permlane16_swap_b32 v225, v229
    v_permlane16_swap_b32 v226, v230
    v_permlane16_swap_b32 v227, v231
    buffer_store_dwordx4 v[216:219], v41, s[28:31], s48 offen offset:0 sc1
    buffer_store_dwordx4 v[220:223], v41, s[28:31], s48 offen offset:1024 sc1
    buffer_store_dwordx4 v[224:227], v41, s[28:31], s49 offen offset:0 sc1
    buffer_store_dwordx4 v[228:231], v41, s[28:31], s49 offen offset:1024 sc1
    s_barrier
    buffer_load_dword v15, v14, s[32:35], s78 offen sc1
    s_sub_u32 s92, s89, 7
    s_cmp_ge_u32 s92, s99
    s_cselect_b32 s98, 7, 0
    s_add_u32 s92, s92, s98
    s_add_u32 s98, s89, s99
    s_cmp_lt_u32 s89, 7
    s_cselect_b32 s91, s98, s92
    s_add_u32 s89, s89, 2
    s_lshl_b32 s91, s91, 16
    s_add_u32 s91, s91, s83
    s_add_u32 s55, s91, 16384
    s_add_u32 m0, s84, 0
    s_nop 0
    buffer_load_dwordx4 v8, s[12:15], s91 offen  lds
    s_add_u32 m0, s84, 1024
    s_nop 0
    buffer_load_dwordx4 v9, s[12:15], s91 offen  lds
    s_add_u32 m0, s84, 2048
    s_nop 0
    buffer_load_dwordx4 v8, s[12:15], s55 offen  lds
    s_add_u32 m0, s84, 3072
    s_nop 0
    buffer_load_dwordx4 v9, s[12:15], s55 offen  lds
    s_nop 3
    v_cvt_pk_bf16_f32 v96, v64, v65
    v_cvt_pk_bf16_f32 v104, -v80, -v81
    v_cvt_pk_bf16_f32 v97, v66, v67
    v_cvt_pk_bf16_f32 v105, -v82, -v83
    v_cvt_pk_bf16_f32 v98, v68, v69
    v_cvt_pk_bf16_f32 v106, -v84, -v85
    v_cvt_pk_bf16_f32 v99, v70, v71
    v_cvt_pk_bf16_f32 v107, -v86, -v87
    v_cvt_pk_bf16_f32 v100, v72, v73
    v_cvt_pk_bf16_f32 v108, -v88, -v89
    v_cvt_pk_bf16_f32 v101, v74, v75
    v_cvt_pk_bf16_f32 v109, -v90, -v91
    v_cvt_pk_bf16_f32 v102, v76, v77
    v_cvt_pk_bf16_f32 v110, -v92, -v93
    v_cvt_pk_bf16_f32 v103, v78, v79
    v_cvt_pk_bf16_f32 v111, -v94, -v95
    s_nop 1
    v_permlane32_swap_b32 v96, v98
    v_permlane32_swap_b32 v97, v99
    v_permlane32_swap_b32 v100, v102
    v_permlane32_swap_b32 v101, v103
    v_permlane32_swap_b32 v104, v106
    v_permlane32_swap_b32 v105, v107
    v_permlane32_swap_b32 v108, v110
    v_permlane32_swap_b32 v109, v111
    s_nop 0
    v_permlane16_swap_b32 v96, v100
    v_permlane16_swap_b32 v97, v101
    v_permlane16_swap_b32 v98, v102
    v_permlane16_swap_b32 v99, v103
    v_permlane16_swap_b32 v104, v108
    v_permlane16_swap_b32 v105, v109
    v_permlane16_swap_b32 v106, v110
    v_permlane16_swap_b32 v107, v111
    buffer_store_dwordx4 v[96:99], v41, s[28:31], s50 offen offset:0 sc1
    buffer_store_dwordx4 v[100:103], v41, s[28:31], s50 offen offset:1024 sc1
    buffer_store_dwordx4 v[104:107], v41, s[28:31], s51 offen offset:0 sc1
    buffer_store_dwordx4 v[108:111], v41, s[28:31], s51 offen offset:1024 sc1
    s_waitcnt vmcnt(8)
    s_mov_b32 s73, 0
    v_cmp_ne_u32 vcc, s94, v15
    s_nop 1
    s_and_b32 s60, vcc_lo, s81
    s_cmp_eq_u32 s60, 0
    s_cbranch_scc1 hp_done_10
hp_spin_9:
    buffer_load_dword v15, v14, s[32:35], s78 offen sc1
    s_waitcnt vmcnt(0)
    v_cmp_ne_u32 vcc, s94, v15
    s_nop 1
    s_and_b32 s60, vcc_lo, s81
    s_cmp_eq_u32 s60, 0
    s_cbranch_scc1 hp_done_10
    s_sleep 1
    s_add_u32 s73, s73, 1
    s_cmp_lt_u32 s73, 0x8000
    s_cbranch_scc1 hp_spin_9
hp_done_10:
    s_mov_b32 s81, vcc_lo
    s_add_u32 m0, s96, 98304
    s_sub_u32 s92, s90, 7
    s_cmp_ge_u32 s92, s99
    s_cselect_b32 s98, 7, 0
    s_add_u32 s92, s92, s98
    s_add_u32 s98, s90, s99
    s_cmp_lt_u32 s90, 7
    s_cselect_b32 s91, s98, s92
    s_add_u32 s90, s90, 2
    s_lshl_b32 s91, s91, 13
    s_add_u32 s91, s91, s82
    s_cmp_eq_u32 s100, 0
    s_cbranch_scc1 L_skipA3
    buffer_load_dwordx4 v5, s[24:27], s91 offen offset:0 sc1 lds
    buffer_load_dwordx4 v5, s[24:27], s91 offen offset:1024 sc1 lds
    buffer_load_dwordx4 v5, s[24:27], s91 offen offset:2048 sc1 lds
    buffer_load_dwordx4 v5, s[24:27], s91 offen offset:3072 sc1 lds
L_skipA3:
    s_add_u32 m0, s96, 0
    s_sub_u32 s92, s90, 7
    s_cmp_ge_u32 s92, s99
    s_cselect_b32 s98, 7, 0
    s_add_u32 s92, s92, s98
    s_add_u32 s98, s90, s99
    s_cmp_lt_u32 s90, 7
    s_cselect_b32 s91, s98, s92
    s_add_u32 s90, s90, 2
    s_lshl_b32 s91, s91, 13
    s_add_u32 s91, s91, s82
    buffer_load_dwordx4 v5, s[24:27], s91 offen offset:0 sc1 lds
    buffer_load_dwordx4 v5, s[24:27], s91 offen offset:1024 sc1 lds
    buffer_load_dwordx4 v5, s[24:27], s91 offen offset:2048 sc1 lds
    buffer_load_dwordx4 v5, s[24:27], s91 offen offset:3072 sc1 lds
    s_sub_u32 s92, s89, 7
    s_cmp_ge_u32 s92, s99
    s_cselect_b32 s98, 7, 0
    s_add_u32 s92, s92, s98
    s_add_u32 s98, s89, s99
    s_cmp_lt_u32 s89, 7
    s_cselect_b32 s52, s98, s92
    s_add_u32 s89, s89, 2
    s_lshl_b32 s53, s52, 13
    s_lshl_b32 s52, s52, 16
    s_add_u32 s90, s90, 2
    s_add_u32 s52, s52, s83
    s_add_u32 s53, s53, s82
    s_add_u32 s54, s52, 16384
    s_add_u32 m0, s96, 32768
    s_barrier
    buffer_load_dwordx4 v5, s[24:27], s53 offen offset:0 sc1 lds
    buffer_load_dwordx4 v5, s[24:27], s53 offen offset:1024 sc1 lds
    buffer_load_dwordx4 v5, s[24:27], s53 offen offset:2048 sc1 lds
    buffer_load_dwordx4 v5, s[24:27], s53 offen offset:3072 sc1 lds
    s_add_u32 m0, s84, 32768
    s_nop 0
    buffer_load_dwordx4 v8, s[12:15], s52 offen  lds
    s_add_u32 m0, s84, 33792
    s_nop 0
    buffer_load_dwordx4 v9, s[12:15], s52 offen  lds
    s_add_u32 m0, s84, 34816
    s_nop 0
    buffer_load_dwordx4 v8, s[12:15], s54 offen  lds
    s_add_u32 m0, s84, 35840
    s_nop 0
    buffer_load_dwordx4 v9, s[12:15], s54 offen  lds
    s_sub_u32 s92, s89, 7
    s_cmp_ge_u32 s92, s99
    s_cselect_b32 s98, 7, 0
    s_add_u32 s92, s92, s98
    s_add_u32 s98, s89, s99
    s_cmp_lt_u32 s89, 7
    s_cselect_b32 s52, s98, s92
    s_add_u32 s89, s89, 2
    s_lshl_b32 s53, s52, 13
    s_lshl_b32 s52, s52, 16
    s_add_u32 s90, s90, 2
    s_add_u32 s52, s52, s83
    s_add_u32 s53, s53, s82
    s_add_u32 s54, s52, 16384
    s_add_u32 m0, s96, 65536
    s_waitcnt vmcnt(12)
    s_barrier
    buffer_load_dwordx4 v5, s[24:27], s53 offen offset:0 sc1 lds
    buffer_load_dwordx4 v5, s[24:27], s53 offen offset:1024 sc1 lds
    buffer_load_dwordx4 v5, s[24:27], s53 offen offset:2048 sc1 lds
    buffer_load_dwordx4 v5, s[24:27], s53 offen offset:3072 sc1 lds
    s_add_u32 m0, s84, 65536
    s_nop 0
    buffer_load_dwordx4 v8, s[12:15], s52 offen  lds
    s_add_u32 m0, s84, 66560
    s_nop 0
    buffer_load_dwordx4 v9, s[12:15], s52 offen  lds
    s_add_u32 m0, s84, 67584
    s_nop 0
    buffer_load_dwordx4 v8, s[12:15], s54 offen  lds
    s_add_u32 m0, s84, 68608
    s_nop 0
    buffer_load_dwordx4 v9, s[12:15], s54 offen  lds
    s_sub_u32 s92, s89, 7
    s_cmp_ge_u32 s92, s99
    s_cselect_b32 s98, 7, 0
    s_add_u32 s92, s92, s98
    s_add_u32 s98, s89, s99
    s_cmp_lt_u32 s89, 7
    s_cselect_b32 s52, s98, s92
    s_add_u32 s89, s89, 2
    s_lshl_b32 s53, s52, 13
    s_lshl_b32 s52, s52, 16
    s_add_u32 s90, s90, 2
    s_add_u32 s52, s52, s83
    s_add_u32 s53, s53, s82
    s_add_u32 s54, s52, 16384
    s_add_u32 m0, s96, 98304
    s_waitcnt vmcnt(16)
    s_barrier
    s_cmp_eq_u32 s81, 0
    s_cbranch_scc1 L_h2skip
    s_mov_b32 s73, 0
hp2_spin_11:
    buffer_load_dword v15, v14, s[32:35], s78 offen sc1
    s_waitcnt vmcnt(0)
    v_cmp_ne_u32 vcc, s94, v15
    s_nop 1
    s_cmp_eq_u64 vcc, 0
    s_cbranch_scc1 hp2_done_12
    s_sleep 1
    s_add_u32 s73, s73, 1
    s_cmp_lt_u32 s73, 0x8000
    s_cbranch_scc1 hp2_spin_11
hp2_done_12:
L_h2skip:
    buffer_load_dwordx4 v5, s[24:27], s53 offen offset:0 sc1 lds
    buffer_load_dwordx4 v5, s[24:27], s53 offen offset:1024 sc1 lds
    buffer_load_dwordx4 v5, s[24:27], s53 offen offset:2048 sc1 lds
    buffer_load_dwordx4 v5, s[24:27], s53 offen offset:3072 sc1 lds
    s_add_u32 m0, s84, 98304
    s_nop 0
    buffer_load_dwordx4 v8, s[12:15], s52 offen  lds
    s_add_u32 m0, s84, 99328
    s_nop 0
    buffer_load_dwordx4 v9, s[12:15], s52 offen  lds
    s_add_u32 m0, s84, 100352
    s_nop 0
    buffer_load_dwordx4 v8, s[12:15], s54 offen  lds
    s_add_u32 m0, s84, 101376
    s_nop 0
    buffer_load_dwordx4 v9, s[12:15], s54 offen  lds
    s_sub_u32 s92, s89, 7
    s_cmp_ge_u32 s92, s99
    s_cselect_b32 s98, 7, 0
    s_add_u32 s92, s92, s98
    s_add_u32 s98, s89, s99
    s_cmp_lt_u32 s89, 7
    s_cselect_b32 s52, s98, s92
    s_add_u32 s89, s89, 2
    s_lshl_b32 s53, s52, 13
    s_lshl_b32 s52, s52, 16
    s_add_u32 s90, s90, 2
    s_add_u32 s52, s52, s83
    s_add_u32 s53, s53, s82
    s_add_u32 s54, s52, 16384
    s_add_u32 m0, s96, 0
    s_waitcnt vmcnt(16)
    s_barrier
    buffer_load_dwordx4 v5, s[24:27], s53 offen offset:0 sc1 lds
    buffer_load_dwordx4 v5, s[24:27], s53 offen offset:1024 sc1 lds
    buffer_load_dwordx4 v5, s[24:27], s53 offen offset:2048 sc1 lds
    buffer_load_dwordx4 v5, s[24:27], s53 offen offset:3072 sc1 lds
    s_add_u32 m0, s84, 0
    s_nop 0
    buffer_load_dwordx4 v8, s[12:15], s52 offen  lds
    s_add_u32 m0, s84, 1024
    s_nop 0
    buffer_load_dwordx4 v9, s[12:15], s52 offen  lds
    s_add_u32 m0, s84, 2048
    s_nop 0
    buffer_load_dwordx4 v8, s[12:15], s54 offen  lds
    s_add_u32 m0, s84, 3072
    s_nop 0
    buffer_load_dwordx4 v9, s[12:15], s54 offen  lds
    s_mov_b64 exec, 1
    buffer_store_dword v60, v16, s[32:35], s93 offen sc1
    s_mov_b64 exec, -1
    s_sub_u32 s92, s89, 7
    s_cmp_ge_u32 s92, s99
    s_cselect_b32 s98, 7, 0
    s_add_u32 s92, s92, s98
    s_add_u32 s98, s89, s99
    s_cmp_lt_u32 s89, 7
    s_cselect_b32 s52, s98, s92
    s_add_u32 s89, s89, 2
    s_lshl_b32 s53, s52, 13
    s_lshl_b32 s52, s52, 16
    s_add_u32 s90, s90, 2
    s_add_u32 s52, s52, s83
    s_add_u32 s53, s53, s82
    s_add_u32 s54, s52, 16384
    s_add_u32 m0, s96, 32768
    s_waitcnt vmcnt(17)
    s_barrier
    buffer_load_dwordx4 v5, s[24:27], s53 offen offset:0 sc1 lds
    buffer_load_dwordx4 v5, s[24:27], s53 offen offset:1024 sc1 lds
    buffer_load_dwordx4 v5, s[24:27], s53 offen offset:2048 sc1 lds
    buffer_load_dwordx4 v5, s[24:27], s53 offen offset:3072 sc1 lds
    s_add_u32 m0, s84, 32768
    s_nop 0
    buffer_load_dwordx4 v8, s[12:15], s52 offen  lds
    s_add_u32 m0, s84, 33792
    s_nop 0
    buffer_load_dwordx4 v9, s[12:15], s52 offen  lds
    s_add_u32 m0, s84, 34816
    s_nop 0
    buffer_load_dwordx4 v8, s[12:15], s54 offen  lds
    s_add_u32 m0, s84, 35840
    s_nop 0
    buffer_load_dwordx4 v9, s[12:15], s54 offen  lds
    s_sub_u32 s92, s89, 7
    s_cmp_ge_u32 s92, s99
    s_cselect_b32 s98, 7, 0
    s_add_u32 s92, s92, s98
    s_add_u32 s98, s89, s99
    s_cmp_lt_u32 s89, 7
    s_cselect_b32 s52, s98, s92
    s_add_u32 s89, s89, 2
    s_lshl_b32 s53, s52, 13
    s_lshl_b32 s52, s52, 16
    s_add_u32 s90, s90, 2
    s_add_u32 s52, s52, s83
    s_add_u32 s53, s53, s82
    s_add_u32 s54, s52, 16384
    s_add_u32 m0, s96, 65536
    s_waitcnt vmcnt(17)
    s_barrier
    buffer_load_dwordx4 v5, s[24:27], s53 offen offset:0 sc1 lds
    buffer_load_dwordx4 v5, s[24:27], s53 offen offset:1024 sc1 lds
    buffer_load_dwordx4 v5, s[24:27], s53 offen offset:2048 sc1 lds
    buffer_load_dwordx4 v5, s[24:27], s53 offen offset:3072 sc1 lds
    s_add_u32 m0, s84, 65536
    s_nop 0
    buffer_load_dwordx4 v8, s[12:15], s52 offen  lds
    s_add_u32 m0, s84, 66560
    s_nop 0
    buffer_load_dwordx4 v9, s[12:15], s52 offen  lds
    s_add_u32 m0, s84, 67584
    s_nop 0
    buffer_load_dwordx4 v8, s[12:15], s54 offen  lds
    s_add_u32 m0, s84, 68608
    s_nop 0
    buffer_load_dwordx4 v9, s[12:15], s54 offen  lds
    s_mov_b32 s86, 0
L_h_g2loop:
    s_sub_u32 s92, s89, 7
    s_cmp_ge_u32 s92, s99
    s_cselect_b32 s98, 7, 0
    s_add_u32 s92, s92, s98
    s_add_u32 s98, s89, s99
    s_cmp_lt_u32 s89, 7
    s_cselect_b32 s52, s98, s92
    s_add_u32 s89, s89, 2
    s_lshl_b32 s53, s52, 13
    s_lshl_b32 s52, s52, 16
    s_add_u32 s90, s90, 2
    s_add_u32 s52, s52, s83
    s_add_u32 s53, s53, s82
    s_add_u32 s54, s52, 16384
    s_add_u32 m0, s96, 98304
    s_waitcnt vmcnt(16)
    s_barrier
    buffer_load_dwordx4 v5, s[24:27], s53 offen offset:0 sc1 lds
    buffer_load_dwordx4 v5, s[24:27], s53 offen offset:1024 sc1 lds
    buffer_load_dwordx4 v5, s[24:27], s53 offen offset:2048 sc1 lds
    buffer_load_dwordx4 v5, s[24:27], s53 offen offset:3072 sc1 lds
    s_add_u32 m0, s84, 98304
    s_nop 0
    buffer_load_dwordx4 v8, s[12:15], s52 offen  lds
    s_add_u32 m0, s84, 99328
    s_nop 0
    buffer_load_dwordx4 v9, s[12:15], s52 offen  lds
    s_add_u32 m0, s84, 100352
    s_nop 0
    buffer_load_dwordx4 v8, s[12:15], s54 offen  lds
    s_add_u32 m0, s84, 101376
    s_nop 0
    buffer_load_dwordx4 v9, s[12:15], s54 offen  lds
    s_sub_u32 s92, s89, 7
    s_cmp_ge_u32 s92, s99
    s_cselect_b32 s98, 7, 0
    s_add_u32 s92, s92, s98
    s_add_u32 s98, s89, s99
    s_cmp_lt_u32 s89, 7
    s_cselect_b32 s52, s98, s92
    s_add_u32 s89, s89, 2
    s_lshl_b32 s53, s52, 13
    s_lshl_b32 s52, s52, 16
    s_add_u32 s90, s90, 2
    s_add_u32 s52, s52, s83
    s_add_u32 s53, s53, s82
    s_add_u32 s54, s52, 16384
    s_add_u32 m0, s96, 0
    s_waitcnt vmcnt(16)
    s_barrier
    buffer_load_dwordx4 v5, s[24:27], s53 offen offset:0 sc1 lds
    buffer_load_dwordx4 v5, s[24:27], s53 offen offset:1024 sc1 lds
    buffer_load_dwordx4 v5, s[24:27], s53 offen offset:2048 sc1 lds
    buffer_load_dwordx4 v5, s[24:27], s53 offen offset:3072 sc1 lds
    s_add_u32 m0, s84, 0
    s_nop 0
    buffer_load_dwordx4 v8, s[12:15], s52 offen  lds
    s_add_u32 m0, s84, 1024
    s_nop 0
    buffer_load_dwordx4 v9, s[12:15], s52 offen  lds
    s_add_u32 m0, s84, 2048
    s_nop 0
    buffer_load_dwordx4 v8, s[12:15], s54 offen  lds
    s_add_u32 m0, s84, 3072
    s_nop 0
    buffer_load_dwordx4 v9, s[12:15], s54 offen  lds
    s_sub_u32 s92, s89, 7
    s_cmp_ge_u32 s92, s99
    s_cselect_b32 s98, 7, 0
    s_add_u32 s92, s92, s98
    s_add_u32 s98, s89, s99
    s_cmp_lt_u32 s89, 7
    s_cselect_b32 s52, s98, s92
    s_add_u32 s89, s89, 2
    s_lshl_b32 s53, s52, 13
    s_lshl_b32 s52, s52, 16
    s_add_u32 s90, s90, 2
    s_add_u32 s52, s52, s83
    s_add_u32 s53, s53, s82
    s_add_u32 s54, s52, 16384
    s_add_u32 m0, s96, 32768
    s_waitcnt vmcnt(16)
    s_barrier
    buffer_load_dwordx4 v5, s[24:27], s53 offen offset:0 sc1 lds
    buffer_load_dwordx4 v5, s[24:27], s53 offen offset:1024 sc1 lds
    buffer_load_dwordx4 v5, s[24:27], s53 offen offset:2048 sc1 lds
    buffer_load_dwordx4 v5, s[24:27], s53 offen offset:3072 sc1 lds
    s_add_u32 m0, s84, 32768
    s_nop 0
    buffer_load_dwordx4 v8, s[12:15], s52 offen  lds
    s_add_u32 m0, s84, 33792
    s_nop 0
    buffer_load_dwordx4 v9, s[12:15], s52 offen  lds
    s_add_u32 m0, s84, 34816
    s_nop 0
    buffer_load_dwordx4 v8, s[12:15], s54 offen  lds
    s_add_u32 m0, s84, 35840
    s_nop 0
    buffer_load_dwordx4 v9, s[12:15], s54 offen  lds
    s_sub_u32 s92, s89, 7
    s_cmp_ge_u32 s92, s99
    s_cselect_b32 s98, 7, 0
    s_add_u32 s92, s92, s98
    s_add_u32 s98, s89, s99
    s_cmp_lt_u32 s89, 7
    s_cselect_b32 s52, s98, s92
    s_add_u32 s89, s89, 2
    s_lshl_b32 s53, s52, 13
    s_lshl_b32 s52, s52, 16
    s_add_u32 s90, s90, 2
    s_add_u32 s52, s52, s83
    s_add_u32 s53, s53, s82
    s_add_u32 s54, s52, 16384
    s_add_u32 m0, s96, 65536
    s_waitcnt vmcnt(16)
    s_barrier
    buffer_load_dwordx4 v5, s[24:27], s53 offen offset:0 sc1 lds
    buffer_load_dwordx4 v5, s[24:27], s53 offen offset:1024 sc1 lds
    buffer_load_dwordx4 v5, s[24:27], s53 offen offset:2048 sc1 lds
    buffer_load_dwordx4 v5, s[24:27], s53 offen offset:3072 sc1 lds
    s_add_u32 m0, s84, 65536
    s_nop 0
    buffer_load_dwordx4 v8, s[12:15], s52 offen  lds
    s_add_u32 m0, s84, 66560
    s_nop 0
    buffer_load_dwordx4 v9, s[12:15], s52 offen  lds
    s_add_u32 m0, s84, 67584
    s_nop 0
    buffer_load_dwordx4 v8, s[12:15], s54 offen  lds
    s_add_u32 m0, s84, 68608
    s_nop 0
    buffer_load_dwordx4 v9, s[12:15], s54 offen  lds
    s_add_u32 s86, s86, 1
    s_cmp_lt_u32 s86, 3
    s_cbranch_scc1 L_h_g2loop
    s_sub_u32 s92, s89, 7
    s_cmp_ge_u32 s92, s99
    s_cselect_b32 s98, 7, 0
    s_add_u32 s92, s92, s98
    s_add_u32 s98, s89, s99
    s_cmp_lt_u32 s89, 7
    s_cselect_b32 s52, s98, s92
    s_add_u32 s89, s89, 2
    s_lshl_b32 s53, s52, 13
    s_lshl_b32 s52, s52, 16
    s_add_u32 s90, s90, 2
    s_add_u32 s52, s52, s83
    s_add_u32 s53, s53, s82
    s_add_u32 s54, s52, 16384
    s_add_u32 m0, s96, 98304
    s_waitcnt vmcnt(16)
    s_barrier
    buffer_load_dwordx4 v5, s[24:27], s53 offen offset:0 sc1 lds
    buffer_load_dwordx4 v5, s[24:27], s53 offen offset:1024 sc1 lds
    buffer_load_dwordx4 v5, s[24:27], s53 offen offset:2048 sc1 lds
    buffer_load_dwordx4 v5, s[24:27], s53 offen offset:3072 sc1 lds
    s_add_u32 m0, s84, 98304
    s_nop 0
    buffer_load_dwordx4 v8, s[12:15], s52 offen  lds
    s_add_u32 m0, s84, 99328
    s_nop 0
    buffer_load_dwordx4 v9, s[12:15], s52 offen  lds
    s_add_u32 m0, s84, 100352
    s_nop 0
    buffer_load_dwordx4 v8, s[12:15], s54 offen  lds
    s_add_u32 m0, s84, 101376
    s_nop 0
    buffer_load_dwordx4 v9, s[12:15], s54 offen  lds
    s_sub_u32 s92, s89, 7
    s_cmp_ge_u32 s92, s99
    s_cselect_b32 s98, 7, 0
    s_add_u32 s92, s92, s98
    s_add_u32 s98, s89, s99
    s_cmp_lt_u32 s89, 7
    s_cselect_b32 s52, s98, s92
    s_add_u32 s89, s89, 2
    s_lshl_b32 s53, s52, 13
    s_lshl_b32 s52, s52, 16
    s_add_u32 s90, s90, 2
    s_add_u32 s52, s52, s83
    s_add_u32 s53, s53, s82
    s_add_u32 s54, s52, 16384
    s_add_u32 m0, s96, 0
    s_waitcnt vmcnt(16)
    s_barrier
    buffer_load_dwordx4 v5, s[24:27], s53 offen offset:0 sc1 lds
    buffer_load_dwordx4 v5, s[24:27], s53 offen offset:1024 sc1 lds
    buffer_load_dwordx4 v5, s[24:27], s53 offen offset:2048 sc1 lds
    buffer_load_dwordx4 v5, s[24:27], s53 offen offset:3072 sc1 lds
    s_add_u32 m0, s84, 0
    s_nop 0
    buffer_load_dwordx4 v8, s[12:15], s52 offen  lds
    s_add_u32 m0, s84, 1024
    s_nop 0
    buffer_load_dwordx4 v9, s[12:15], s52 offen  lds
    s_add_u32 m0, s84, 2048
    s_nop 0
    buffer_load_dwordx4 v8, s[12:15], s54 offen  lds
    s_add_u32 m0, s84, 3072
    s_nop 0
    buffer_load_dwordx4 v9, s[12:15], s54 offen  lds
    s_cmp_lg_u32 s46, 2
    s_cbranch_scc1 ct_13
    s_getpc_b64 s[60:61]
pc_14:
    s_sub_u32 s60, s60, pc_14-recurrent_scan__spectral_fnet__dense_activation_silu__prompt_kernel
    s_subb_u32 s61, s61, 0
    s_lshr_b32 s62, s2, 3
    s_lshl_b32 s62, s62, 11
    v_lshlrev_b32 v10, 7, v1
    v_add_u32 v10, s62, v10
    v_min_u32 v10, L_end-recurrent_scan__spectral_fnet__dense_activation_silu__prompt_kernel, v10
    s_mov_b64 exec, 0xffff
    global_load_dword v11, v10, s[60:61]
    s_mov_b64 exec, -1
ct_13:
    s_sub_u32 s92, s89, 7
    s_cmp_ge_u32 s92, s99
    s_cselect_b32 s98, 7, 0
    s_add_u32 s92, s92, s98
    s_add_u32 s98, s89, s99
    s_cmp_lt_u32 s89, 7
    s_cselect_b32 s52, s98, s92
    s_add_u32 s89, s89, 2
    s_lshl_b32 s53, s52, 13
    s_lshl_b32 s52, s52, 16
    s_add_u32 s90, s90, 2
    s_add_u32 s52, s52, s83
    s_add_u32 s53, s53, s82
    s_add_u32 s54, s52, 16384
    s_add_u32 m0, s96, 32768
    s_waitcnt vmcnt(16)
    s_barrier
    buffer_load_dwordx4 v5, s[24:27], s53 offen offset:0 sc1 lds
    buffer_load_dwordx4 v5, s[24:27], s53 offen offset:1024 sc1 lds
    buffer_load_dwordx4 v5, s[24:27], s53 offen offset:2048 sc1 lds
    buffer_load_dwordx4 v5, s[24:27], s53 offen offset:3072 sc1 lds
    s_add_u32 m0, s84, 32768
    s_nop 0
    buffer_load_dwordx4 v8, s[12:15], s52 offen  lds
    s_add_u32 m0, s84, 33792
    s_nop 0
    buffer_load_dwordx4 v9, s[12:15], s52 offen  lds
    s_add_u32 m0, s84, 34816
    s_nop 0
    buffer_load_dwordx4 v8, s[12:15], s54 offen  lds
    s_add_u32 m0, s84, 35840
    s_nop 0
    buffer_load_dwordx4 v9, s[12:15], s54 offen  lds
    buffer_load_dwordx4 v[52:55], v240, s[32:35], s97 offen sc1
    s_sub_u32 s92, s89, 7
    s_cmp_ge_u32 s92, s99
    s_cselect_b32 s98, 7, 0
    s_add_u32 s92, s92, s98
    s_add_u32 s98, s89, s99
    s_cmp_lt_u32 s89, 7
    s_cselect_b32 s52, s98, s92
    s_add_u32 s89, s89, 2
    s_lshl_b32 s53, s52, 13
    s_lshl_b32 s52, s52, 16
    s_add_u32 s90, s90, 2
    s_add_u32 s52, s52, s83
    s_add_u32 s53, s53, s82
    s_add_u32 s54, s52, 16384
    s_add_u32 m0, s96, 65536
    s_waitcnt vmcnt(17)
    s_barrier
    buffer_load_dwordx4 v5, s[24:27], s53 offen offset:0 sc1 lds
    buffer_load_dwordx4 v5, s[24:27], s53 offen offset:1024 sc1 lds
    buffer_load_dwordx4 v5, s[24:27], s53 offen offset:2048 sc1 lds
    buffer_load_dwordx4 v5, s[24:27], s53 offen offset:3072 sc1 lds
    s_add_u32 m0, s84, 65536
    s_nop 0
    buffer_load_dwordx4 v8, s[12:15], s52 offen  lds
    s_add_u32 m0, s84, 66560
    s_nop 0
    buffer_load_dwordx4 v9, s[12:15], s52 offen  lds
    s_add_u32 m0, s84, 67584
    s_nop 0
    buffer_load_dwordx4 v8, s[12:15], s54 offen  lds
    s_add_u32 m0, s84, 68608
    s_nop 0
    buffer_load_dwordx4 v9, s[12:15], s54 offen  lds
    s_sub_u32 s92, s89, 7
    s_cmp_ge_u32 s92, s99
    s_cselect_b32 s98, 7, 0
    s_add_u32 s92, s92, s98
    s_add_u32 s98, s89, s99
    s_cmp_lt_u32 s89, 7
    s_cselect_b32 s52, s98, s92
    s_add_u32 s89, s89, 2
    s_lshl_b32 s53, s52, 13
    s_lshl_b32 s52, s52, 16
    s_add_u32 s90, s90, 2
    s_add_u32 s52, s52, s83
    s_add_u32 s53, s53, s82
    s_add_u32 s54, s52, 16384
    s_add_u32 m0, s96, 98304
    s_waitcnt vmcnt(17)
    s_barrier
    buffer_load_dwordx4 v5, s[24:27], s53 offen offset:0 sc1 lds
    buffer_load_dwordx4 v5, s[24:27], s53 offen offset:1024 sc1 lds
    buffer_load_dwordx4 v5, s[24:27], s53 offen offset:2048 sc1 lds
    buffer_load_dwordx4 v5, s[24:27], s53 offen offset:3072 sc1 lds
    s_add_u32 m0, s84, 98304
    s_nop 0
    buffer_load_dwordx4 v8, s[12:15], s52 offen  lds
    s_add_u32 m0, s84, 99328
    s_nop 0
    buffer_load_dwordx4 v9, s[12:15], s52 offen  lds
    s_add_u32 m0, s84, 100352
    s_nop 0
    buffer_load_dwordx4 v8, s[12:15], s54 offen  lds
    s_add_u32 m0, s84, 101376
    s_nop 0
    buffer_load_dwordx4 v9, s[12:15], s54 offen  lds
    s_waitcnt vmcnt(17)
    s_barrier
    s_waitcnt vmcnt(16)
    s_mov_b32 s73, 0
    v_xor_b32 v52, s94, v52
    v_xor_b32 v53, s94, v53
    v_xor_b32 v54, s94, v54
    v_xor_b32 v55, s94, v55
    v_or_b32 v52, v52, v53
    v_or3_b32 v52, v52, v54, v55
    v_cmp_ne_u32 vcc, 0, v52
    s_nop 1
    s_cmp_eq_u64 vcc, 0
    s_cbranch_scc1 qp_done_16
qp_spin_15:
    buffer_load_dwordx4 v[52:55], v240, s[32:35], s97 offen sc1
    s_waitcnt vmcnt(0)
    v_xor_b32 v52, s94, v52
    v_xor_b32 v53, s94, v53
    v_xor_b32 v54, s94, v54
    v_xor_b32 v55, s94, v55
    v_or_b32 v52, v52, v53
    v_or3_b32 v52, v52, v54, v55
    v_cmp_ne_u32 vcc, 0, v52
    s_nop 1
    s_cmp_eq_u64 vcc, 0
    s_cbranch_scc1 qp_done_16
    s_sleep 1
    s_add_u32 s73, s73, 1
    s_cmp_lt_u32 s73, 0x8000
    s_cbranch_scc1 qp_spin_15
qp_done_16:
    s_add_u32 m0, s85, 0
    s_nop 0
    buffer_load_dwordx4 v240, s[24:27], s87 offen offset:0 sc1 lds
    buffer_load_dwordx4 v240, s[24:27], s87 offen offset:1024 sc1 lds
    s_add_u32 s87, s87, 16384
    s_add_u32 s55, s88, 16384
    s_add_u32 m0, s84, 0
    s_nop 0
    buffer_load_dwordx4 v6, s[28:31], s88 offen sc1 lds
    s_add_u32 m0, s84, 1024
    s_nop 0
    buffer_load_dwordx4 v7, s[28:31], s88 offen sc1 lds
    s_add_u32 m0, s84, 2048
    s_nop 0
    buffer_load_dwordx4 v6, s[28:31], s55 offen sc1 lds
    s_add_u32 m0, s84, 3072
    s_nop 0
    buffer_load_dwordx4 v7, s[28:31], s55 offen sc1 lds
    s_add_u32 s88, s88, 131072
    s_waitcnt vmcnt(14)
    s_barrier
    s_add_u32 m0, s85, 32768
    s_nop 0
    buffer_load_dwordx4 v240, s[24:27], s87 offen offset:0 sc1 lds
    buffer_load_dwordx4 v240, s[24:27], s87 offen offset:1024 sc1 lds
    s_add_u32 s87, s87, 16384
    s_add_u32 s55, s88, 16384
    s_add_u32 m0, s84, 32768
    s_nop 0
    buffer_load_dwordx4 v6, s[28:31], s88 offen sc1 lds
    s_add_u32 m0, s84, 33792
    s_nop 0
    buffer_load_dwordx4 v7, s[28:31], s88 offen sc1 lds
    s_add_u32 m0, s84, 34816
    s_nop 0
    buffer_load_dwordx4 v6, s[28:31], s55 offen sc1 lds
    s_add_u32 m0, s84, 35840
    s_nop 0
    buffer_load_dwordx4 v7, s[28:31], s55 offen sc1 lds
    s_add_u32 s88, s88, 131072
    s_waitcnt vmcnt(12)
    s_barrier
    s_add_u32 m0, s85, 65536
    s_nop 0
    buffer_load_dwordx4 v240, s[24:27], s87 offen offset:0 sc1 lds
    buffer_load_dwordx4 v240, s[24:27], s87 offen offset:1024 sc1 lds
    s_add_u32 s87, s87, 16384
    s_add_u32 s55, s88, 16384
    s_add_u32 m0, s84, 65536
    s_nop 0
    buffer_load_dwordx4 v6, s[28:31], s88 offen sc1 lds
    s_add_u32 m0, s84, 66560
    s_nop 0
    buffer_load_dwordx4 v7, s[28:31], s88 offen sc1 lds
    s_add_u32 m0, s84, 67584
    s_nop 0
    buffer_load_dwordx4 v6, s[28:31], s55 offen sc1 lds
    s_add_u32 m0, s84, 68608
    s_nop 0
    buffer_load_dwordx4 v7, s[28:31], s55 offen sc1 lds
    s_add_u32 s88, s88, 131072
    s_waitcnt vmcnt(12)
    s_barrier
    s_add_u32 m0, s85, 98304
    s_nop 0
    buffer_load_dwordx4 v240, s[24:27], s87 offen offset:0 sc1 lds
    buffer_load_dwordx4 v240, s[24:27], s87 offen offset:1024 sc1 lds
    s_add_u32 s87, s87, 16384
    s_add_u32 s55, s88, 16384
    s_add_u32 m0, s84, 98304
    s_nop 0
    buffer_load_dwordx4 v6, s[28:31], s88 offen sc1 lds
    s_add_u32 m0, s84, 99328
    s_nop 0
    buffer_load_dwordx4 v7, s[28:31], s88 offen sc1 lds
    s_add_u32 m0, s84, 100352
    s_nop 0
    buffer_load_dwordx4 v6, s[28:31], s55 offen sc1 lds
    s_add_u32 m0, s84, 101376
    s_nop 0
    buffer_load_dwordx4 v7, s[28:31], s55 offen sc1 lds
    s_add_u32 s88, s88, 131072
    s_waitcnt vmcnt(12)
    s_barrier
    s_add_u32 m0, s85, 0
    s_nop 0
    buffer_load_dwordx4 v240, s[24:27], s87 offen offset:0 sc1 lds
    buffer_load_dwordx4 v240, s[24:27], s87 offen offset:1024 sc1 lds
    s_add_u32 s87, s87, 16384
    s_add_u32 s55, s88, 16384
    s_add_u32 m0, s84, 0
    s_nop 0
    buffer_load_dwordx4 v6, s[28:31], s88 offen sc1 lds
    s_add_u32 m0, s84, 1024
    s_nop 0
    buffer_load_dwordx4 v7, s[28:31], s88 offen sc1 lds
    s_add_u32 m0, s84, 2048
    s_nop 0
    buffer_load_dwordx4 v6, s[28:31], s55 offen sc1 lds
    s_add_u32 m0, s84, 3072
    s_nop 0
    buffer_load_dwordx4 v7, s[28:31], s55 offen sc1 lds
    s_add_u32 s88, s88, 131072
    s_waitcnt vmcnt(12)
    s_barrier
    s_add_u32 m0, s85, 32768
    s_nop 0
    buffer_load_dwordx4 v240, s[24:27], s87 offen offset:0 sc1 lds
    buffer_load_dwordx4 v240, s[24:27], s87 offen offset:1024 sc1 lds
    s_add_u32 s87, s87, 16384
    s_add_u32 s55, s88, 16384
    s_add_u32 m0, s84, 32768
    s_nop 0
    buffer_load_dwordx4 v6, s[28:31], s88 offen sc1 lds
    s_add_u32 m0, s84, 33792
    s_nop 0
    buffer_load_dwordx4 v7, s[28:31], s88 offen sc1 lds
    s_add_u32 m0, s84, 34816
    s_nop 0
    buffer_load_dwordx4 v6, s[28:31], s55 offen sc1 lds
    s_add_u32 m0, s84, 35840
    s_nop 0
    buffer_load_dwordx4 v7, s[28:31], s55 offen sc1 lds
    s_add_u32 s88, s88, 131072
    s_waitcnt vmcnt(12)
    s_barrier
    s_add_u32 m0, s85, 65536
    s_nop 0
    buffer_load_dwordx4 v240, s[24:27], s87 offen offset:0 sc1 lds
    buffer_load_dwordx4 v240, s[24:27], s87 offen offset:1024 sc1 lds
    s_add_u32 s87, s87, 16384
    s_add_u32 s55, s88, 16384
    s_add_u32 m0, s84, 65536
    s_nop 0
    buffer_load_dwordx4 v6, s[28:31], s88 offen sc1 lds
    s_add_u32 m0, s84, 66560
    s_nop 0
    buffer_load_dwordx4 v7, s[28:31], s88 offen sc1 lds
    s_add_u32 m0, s84, 67584
    s_nop 0
    buffer_load_dwordx4 v6, s[28:31], s55 offen sc1 lds
    s_add_u32 m0, s84, 68608
    s_nop 0
    buffer_load_dwordx4 v7, s[28:31], s55 offen sc1 lds
    s_add_u32 s88, s88, 131072
    s_waitcnt vmcnt(12)
    s_barrier
    s_add_u32 m0, s85, 98304
    s_nop 0
    buffer_load_dwordx4 v240, s[24:27], s87 offen offset:0 sc1 lds
    buffer_load_dwordx4 v240, s[24:27], s87 offen offset:1024 sc1 lds
    s_add_u32 s87, s87, 16384
    s_add_u32 s55, s88, 16384
    s_add_u32 m0, s84, 98304
    s_nop 0
    buffer_load_dwordx4 v6, s[28:31], s88 offen sc1 lds
    s_add_u32 m0, s84, 99328
    s_nop 0
    buffer_load_dwordx4 v7, s[28:31], s88 offen sc1 lds
    s_add_u32 m0, s84, 100352
    s_nop 0
    buffer_load_dwordx4 v6, s[28:31], s55 offen sc1 lds
    s_add_u32 m0, s84, 101376
    s_nop 0
    buffer_load_dwordx4 v7, s[28:31], s55 offen sc1 lds
    s_add_u32 s88, s88, 131072
    s_waitcnt vmcnt(12)
    s_barrier
    s_waitcnt vmcnt(6)
    s_barrier
    s_waitcnt vmcnt(0)
    s_barrier
    s_endpgm
L_epi:
    ds_read_b32 v241, v13
    ds_read_b64 v[156:157], v10 offset:0
    ds_read_b64 v[158:159], v10 offset:128
    ds_read_b64 v[160:161], v10 offset:256
    ds_read_b64 v[162:163], v10 offset:384
    ds_read_b128 v[152:155], v12
    ds_read_b128 v[128:131], v11 offset:0
    ds_read_b128 v[132:135], v11 offset:64
    ds_read_b128 v[136:139], v11 offset:128
    ds_read_b128 v[140:143], v11 offset:192
    ds_read_b128 v[144:147], v11 offset:256
    ds_read_b128 v[148:151], v11 offset:320
    s_waitcnt lgkmcnt(7)
    v_rcp_f32 v164, v157
    v_rcp_f32 v166, v159
    v_rcp_f32 v168, v161
    v_rcp_f32 v170, v163
    s_nop 0
    v_mul_f32 v164, 0xbfb8aa3b, v164
    v_mul_f32 v166, 0xbfb8aa3b, v166
    v_mul_f32 v168, 0xbfb8aa3b, v168
    v_mul_f32 v170, 0xbfb8aa3b, v170
    s_waitcnt lgkmcnt(6)
    v_pk_fma_f32 v[40:41], v[152:153], v[156:157], v[40:41] op_sel_hi:[1,0,1] neg_lo:[0,1,0] neg_hi:[0,1,0]
    v_pk_fma_f32 v[42:43], v[154:155], v[156:157], v[42:43] op_sel_hi:[1,0,1] neg_lo:[0,1,0] neg_hi:[0,1,0]
    v_pk_fma_f32 v[68:69], v[152:153], v[158:159], v[68:69] op_sel_hi:[1,0,1] neg_lo:[0,1,0] neg_hi:[0,1,0]
    v_pk_fma_f32 v[70:71], v[154:155], v[158:159], v[70:71] op_sel_hi:[1,0,1] neg_lo:[0,1,0] neg_hi:[0,1,0]
    v_pk_mul_f32 v[184:185], v[40:41], v[164:165] op_sel_hi:[1,0]
    v_pk_mul_f32 v[186:187], v[42:43], v[164:165] op_sel_hi:[1,0]
    v_pk_mul_f32 v[188:189], v[68:69], v[166:167] op_sel_hi:[1,0]
    v_pk_mul_f32 v[190:191], v[70:71], v[166:167] op_sel_hi:[1,0]
    v_exp_f32 v184, v184
    v_exp_f32 v185, v185
    v_exp_f32 v186, v186
    v_exp_f32 v187, v187
    v_exp_f32 v188, v188
    v_exp_f32 v189, v189
    v_exp_f32 v190, v190
    v_exp_f32 v191, v191
    v_pk_fma_f32 v[184:185], v[184:185], v[156:157], v[156:157] op_sel:[0,1,1] op_sel_hi:[1,1,1]
    v_pk_fma_f32 v[186:187], v[186:187], v[156:157], v[156:157] op_sel:[0,1,1] op_sel_hi:[1,1,1]
    v_pk_fma_f32 v[188:189], v[188:189], v[158:159], v[158:159] op_sel:[0,1,1] op_sel_hi:[1,1,1]
    v_pk_fma_f32 v[190:191], v[190:191], v[158:159], v[158:159] op_sel:[0,1,1] op_sel_hi:[1,1,1]
    v_rcp_f32 v184, v184
    v_rcp_f32 v185, v185
    v_rcp_f32 v186, v186
    v_rcp_f32 v187, v187
    v_rcp_f32 v188, v188
    v_rcp_f32 v189, v189
    v_rcp_f32 v190, v190
    v_rcp_f32 v191, v191
    v_pk_mul_f32 v[184:185], v[184:185], v[40:41]
    v_pk_mul_f32 v[186:187], v[186:187], v[42:43]
    v_pk_mul_f32 v[188:189], v[188:189], v[68:69]
    v_pk_mul_f32 v[190:191], v[190:191], v[70:71]
    v_cvt_pk_bf16_f32 v192, v184, v185
    v_cvt_pk_bf16_f32 v193, v186, v187
    v_cvt_pk_bf16_f32 v194, v188, v189
    v_cvt_pk_bf16_f32 v195, v190, v191
    ds_write_b64 v3, v[192:193] offset:0
    ds_write_b64 v3, v[194:195] offset:1024
    v_pk_fma_f32 v[96:97], v[152:153], v[160:161], v[96:97] op_sel_hi:[1,0,1] neg_lo:[0,1,0] neg_hi:[0,1,0]
    v_pk_fma_f32 v[98:99], v[154:155], v[160:161], v[98:99] op_sel_hi:[1,0,1] neg_lo:[0,1,0] neg_hi:[0,1,0]
    v_pk_fma_f32 v[124:125], v[152:153], v[162:163], v[124:125] op_sel_hi:[1,0,1] neg_lo:[0,1,0] neg_hi:[0,1,0]
    v_pk_fma_f32 v[126:127], v[154:155], v[162:163], v[126:127] op_sel_hi:[1,0,1] neg_lo:[0,1,0] neg_hi:[0,1,0]
    v_pk_mul_f32 v[184:185], v[96:97], v[168:169] op_sel_hi:[1,0]
    v_pk_mul_f32 v[186:187], v[98:99], v[168:169] op_sel_hi:[1,0]
    v_pk_mul_f32 v[188:189], v[124:125], v[170:171] op_sel_hi:[1,0]
    v_pk_mul_f32 v[190:191], v[126:127], v[170:171] op_sel_hi:[1,0]
    v_exp_f32 v184, v184
    v_exp_f32 v185, v185
    v_exp_f32 v186, v186
    v_exp_f32 v187, v187
    v_exp_f32 v188, v188
    v_exp_f32 v189, v189
    v_exp_f32 v190, v190
    v_exp_f32 v191, v191
    v_pk_fma_f32 v[184:185], v[184:185], v[160:161], v[160:161] op_sel:[0,1,1] op_sel_hi:[1,1,1]
    v_pk_fma_f32 v[186:187], v[186:187], v[160:161], v[160:161] op_sel:[0,1,1] op_sel_hi:[1,1,1]
    v_pk_fma_f32 v[188:189], v[188:189], v[162:163], v[162:163] op_sel:[0,1,1] op_sel_hi:[1,1,1]
    v_pk_fma_f32 v[190:191], v[190:191], v[162:163], v[162:163] op_sel:[0,1,1] op_sel_hi:[1,1,1]
    v_rcp_f32 v184, v184
    v_rcp_f32 v185, v185
    v_rcp_f32 v186, v186
    v_rcp_f32 v187, v187
    v_rcp_f32 v188, v188
    v_rcp_f32 v189, v189
    v_rcp_f32 v190, v190
    v_rcp_f32 v191, v191
    v_pk_mul_f32 v[184:185], v[184:185], v[96:97]
    v_pk_mul_f32 v[186:187], v[186:187], v[98:99]
    v_pk_mul_f32 v[188:189], v[188:189], v[124:125]
    v_pk_mul_f32 v[190:191], v[190:191], v[126:127]
    v_cvt_pk_bf16_f32 v196, v184, v185
    v_cvt_pk_bf16_f32 v197, v186, v187
    v_cvt_pk_bf16_f32 v198, v188, v189
    v_cvt_pk_bf16_f32 v199, v190, v191
    ds_write_b64 v3, v[196:197] offset:2048
    ds_write_b64 v3, v[198:199] offset:3072
    s_waitcnt lgkmcnt(0)
    v_pk_fma_f32 v[16:17], v[128:129], v[156:157], v[16:17] op_sel_hi:[1,0,1] neg_lo:[0,1,0] neg_hi:[0,1,0]
    v_pk_fma_f32 v[18:19], v[130:131], v[156:157], v[18:19] op_sel_hi:[1,0,1] neg_lo:[0,1,0] neg_hi:[0,1,0]
    v_pk_fma_f32 v[20:21], v[132:133], v[156:157], v[20:21] op_sel_hi:[1,0,1] neg_lo:[0,1,0] neg_hi:[0,1,0]
    v_pk_fma_f32 v[22:23], v[134:135], v[156:157], v[22:23] op_sel_hi:[1,0,1] neg_lo:[0,1,0] neg_hi:[0,1,0]
    v_pk_mul_f32 v[184:185], v[16:17], v[164:165] op_sel_hi:[1,0]
    v_pk_mul_f32 v[186:187], v[18:19], v[164:165] op_sel_hi:[1,0]
    v_pk_mul_f32 v[188:189], v[20:21], v[164:165] op_sel_hi:[1,0]
    v_pk_mul_f32 v[190:191], v[22:23], v[164:165] op_sel_hi:[1,0]
    v_exp_f32 v184, v184
    v_exp_f32 v185, v185
    v_exp_f32 v186, v186
    v_exp_f32 v187, v187
    v_exp_f32 v188, v188
    v_exp_f32 v189, v189
    v_exp_f32 v190, v190
    v_exp_f32 v191, v191
    v_pk_fma_f32 v[184:185], v[184:185], v[156:157], v[156:157] op_sel:[0,1,1] op_sel_hi:[1,1,1]
    v_pk_fma_f32 v[186:187], v[186:187], v[156:157], v[156:157] op_sel:[0,1,1] op_sel_hi:[1,1,1]
    v_pk_fma_f32 v[188:189], v[188:189], v[156:157], v[156:157] op_sel:[0,1,1] op_sel_hi:[1,1,1]
    v_pk_fma_f32 v[190:191], v[190:191], v[156:157], v[156:157] op_sel:[0,1,1] op_sel_hi:[1,1,1]
    v_rcp_f32 v184, v184
    v_rcp_f32 v185, v185
    v_rcp_f32 v186, v186
    v_rcp_f32 v187, v187
    v_rcp_f32 v188, v188
    v_rcp_f32 v189, v189
    v_rcp_f32 v190, v190
    v_rcp_f32 v191, v191
    v_pk_mul_f32 v[184:185], v[184:185], v[16:17]
    v_pk_mul_f32 v[186:187], v[186:187], v[18:19]
    v_pk_mul_f32 v[188:189], v[188:189], v[20:21]
    v_pk_mul_f32 v[190:191], v[190:191], v[22:23]
    v_cvt_pk_bf16_f32 v172, v184, v185
    v_cvt_pk_bf16_f32 v173, v186, v187
    v_cvt_pk_bf16_f32 v174, v188, v189
    v_cvt_pk_bf16_f32 v175, v190, v191
    ds_write_b128 v6, v[172:175] offset:0
    buffer_store_dwordx4 v[172:175], v2, s[24:27], s49 offen offset:0 sc1
    v_pk_fma_f32 v[44:45], v[128:129], v[158:159], v[44:45] op_sel_hi:[1,0,1] neg_lo:[0,1,0] neg_hi:[0,1,0]
    v_pk_fma_f32 v[46:47], v[130:131], v[158:159], v[46:47] op_sel_hi:[1,0,1] neg_lo:[0,1,0] neg_hi:[0,1,0]
    v_pk_fma_f32 v[48:49], v[132:133], v[158:159], v[48:49] op_sel_hi:[1,0,1] neg_lo:[0,1,0] neg_hi:[0,1,0]
    v_pk_fma_f32 v[50:51], v[134:135], v[158:159], v[50:51] op_sel_hi:[1,0,1] neg_lo:[0,1,0] neg_hi:[0,1,0]
    v_pk_mul_f32 v[184:185], v[44:45], v[166:167] op_sel_hi:[1,0]
    v_pk_mul_f32 v[186:187], v[46:47], v[166:167] op_sel_hi:[1,0]
    v_pk_mul_f32 v[188:189], v[48:49], v[166:167] op_sel_hi:[1,0]
    v_pk_mul_f32 v[190:191], v[50:51], v[166:167] op_sel_hi:[1,0]
    v_exp_f32 v184, v184
    v_exp_f32 v185, v185
    v_exp_f32 v186, v186
    v_exp_f32 v187, v187
    v_exp_f32 v188, v188
    v_exp_f32 v189, v189
    v_exp_f32 v190, v190
    v_exp_f32 v191, v191
    v_pk_fma_f32 v[184:185], v[184:185], v[158:159], v[158:159] op_sel:[0,1,1] op_sel_hi:[1,1,1]
    v_pk_fma_f32 v[186:187], v[186:187], v[158:159], v[158:159] op_sel:[0,1,1] op_sel_hi:[1,1,1]
    v_pk_fma_f32 v[188:189], v[188:189], v[158:159], v[158:159] op_sel:[0,1,1] op_sel_hi:[1,1,1]
    v_pk_fma_f32 v[190:191], v[190:191], v[158:159], v[158:159] op_sel:[0,1,1] op_sel_hi:[1,1,1]
    v_rcp_f32 v184, v184
    v_rcp_f32 v185, v185
    v_rcp_f32 v186, v186
    v_rcp_f32 v187, v187
    v_rcp_f32 v188, v188
    v_rcp_f32 v189, v189
    v_rcp_f32 v190, v190
    v_rcp_f32 v191, v191
    v_pk_mul_f32 v[184:185], v[184:185], v[44:45]
    v_pk_mul_f32 v[186:187], v[186:187], v[46:47]
    v_pk_mul_f32 v[188:189], v[188:189], v[48:49]
    v_pk_mul_f32 v[190:191], v[190:191], v[50:51]
    v_cvt_pk_bf16_f32 v176, v184, v185
    v_cvt_pk_bf16_f32 v177, v186, v187
    v_cvt_pk_bf16_f32 v178, v188, v189
    v_cvt_pk_bf16_f32 v179, v190, v191
    ds_write_b128 v6, v[176:179] offset:1024
    buffer_store_dwordx4 v[176:179], v2, s[24:27], s49 offen offset:1024 sc1
    v_pk_fma_f32 v[72:73], v[128:129], v[160:161], v[72:73] op_sel_hi:[1,0,1] neg_lo:[0,1,0] neg_hi:[0,1,0]
    v_pk_fma_f32 v[74:75], v[130:131], v[160:161], v[74:75] op_sel_hi:[1,0,1] neg_lo:[0,1,0] neg_hi:[0,1,0]
    v_pk_fma_f32 v[76:77], v[132:133], v[160:161], v[76:77] op_sel_hi:[1,0,1] neg_lo:[0,1,0] neg_hi:[0,1,0]
    v_pk_fma_f32 v[78:79], v[134:135], v[160:161], v[78:79] op_sel_hi:[1,0,1] neg_lo:[0,1,0] neg_hi:[0,1,0]
    v_pk_mul_f32 v[184:185], v[72:73], v[168:169] op_sel_hi:[1,0]
    v_pk_mul_f32 v[186:187], v[74:75], v[168:169] op_sel_hi:[1,0]
    v_pk_mul_f32 v[188:189], v[76:77], v[168:169] op_sel_hi:[1,0]
    v_pk_mul_f32 v[190:191], v[78:79], v[168:169] op_sel_hi:[1,0]
    v_exp_f32 v184, v184
    v_exp_f32 v185, v185
    v_exp_f32 v186, v186
    v_exp_f32 v187, v187
    v_exp_f32 v188, v188
    v_exp_f32 v189, v189
    v_exp_f32 v190, v190
    v_exp_f32 v191, v191
    v_pk_fma_f32 v[184:185], v[184:185], v[160:161], v[160:161] op_sel:[0,1,1] op_sel_hi:[1,1,1]
    v_pk_fma_f32 v[186:187], v[186:187], v[160:161], v[160:161] op_sel:[0,1,1] op_sel_hi:[1,1,1]
    v_pk_fma_f32 v[188:189], v[188:189], v[160:161], v[160:161] op_sel:[0,1,1] op_sel_hi:[1,1,1]
    v_pk_fma_f32 v[190:191], v[190:191], v[160:161], v[160:161] op_sel:[0,1,1] op_sel_hi:[1,1,1]
    v_rcp_f32 v184, v184
    v_rcp_f32 v185, v185
    v_rcp_f32 v186, v186
    v_rcp_f32 v187, v187
    v_rcp_f32 v188, v188
    v_rcp_f32 v189, v189
    v_rcp_f32 v190, v190
    v_rcp_f32 v191, v191
    v_pk_mul_f32 v[184:185], v[184:185], v[72:73]
    v_pk_mul_f32 v[186:187], v[186:187], v[74:75]
    v_pk_mul_f32 v[188:189], v[188:189], v[76:77]
    v_pk_mul_f32 v[190:191], v[190:191], v[78:79]
    v_cvt_pk_bf16_f32 v172, v184, v185
    v_cvt_pk_bf16_f32 v173, v186, v187
    v_cvt_pk_bf16_f32 v174, v188, v189
    v_cvt_pk_bf16_f32 v175, v190, v191
    ds_write_b128 v6, v[172:175] offset:2048
    buffer_store_dwordx4 v[172:175], v2, s[24:27], s49 offen offset:2048 sc1
    v_pk_fma_f32 v[100:101], v[128:129], v[162:163], v[100:101] op_sel_hi:[1,0,1] neg_lo:[0,1,0] neg_hi:[0,1,0]
    v_pk_fma_f32 v[102:103], v[130:131], v[162:163], v[102:103] op_sel_hi:[1,0,1] neg_lo:[0,1,0] neg_hi:[0,1,0]
    v_pk_fma_f32 v[104:105], v[132:133], v[162:163], v[104:105] op_sel_hi:[1,0,1] neg_lo:[0,1,0] neg_hi:[0,1,0]
    v_pk_fma_f32 v[106:107], v[134:135], v[162:163], v[106:107] op_sel_hi:[1,0,1] neg_lo:[0,1,0] neg_hi:[0,1,0]
    v_pk_mul_f32 v[184:185], v[100:101], v[170:171] op_sel_hi:[1,0]
    v_pk_mul_f32 v[186:187], v[102:103], v[170:171] op_sel_hi:[1,0]
    v_pk_mul_f32 v[188:189], v[104:105], v[170:171] op_sel_hi:[1,0]
    v_pk_mul_f32 v[190:191], v[106:107], v[170:171] op_sel_hi:[1,0]
    v_exp_f32 v184, v184
    v_exp_f32 v185, v185
    v_exp_f32 v186, v186
    v_exp_f32 v187, v187
    v_exp_f32 v188, v188
    v_exp_f32 v189, v189
    v_exp_f32 v190, v190
    v_exp_f32 v191, v191
    v_pk_fma_f32 v[184:185], v[184:185], v[162:163], v[162:163] op_sel:[0,1,1] op_sel_hi:[1,1,1]
    v_pk_fma_f32 v[186:187], v[186:187], v[162:163], v[162:163] op_sel:[0,1,1] op_sel_hi:[1,1,1]
    v_pk_fma_f32 v[188:189], v[188:189], v[162:163], v[162:163] op_sel:[0,1,1] op_sel_hi:[1,1,1]
    v_pk_fma_f32 v[190:191], v[190:191], v[162:163], v[162:163] op_sel:[0,1,1] op_sel_hi:[1,1,1]
    v_rcp_f32 v184, v184
    v_rcp_f32 v185, v185
    v_rcp_f32 v186, v186
    v_rcp_f32 v187, v187
    v_rcp_f32 v188, v188
    v_rcp_f32 v189, v189
    v_rcp_f32 v190, v190
    v_rcp_f32 v191, v191
    v_pk_mul_f32 v[184:185], v[184:185], v[100:101]
    v_pk_mul_f32 v[186:187], v[186:187], v[102:103]
    v_pk_mul_f32 v[188:189], v[188:189], v[104:105]
    v_pk_mul_f32 v[190:191], v[190:191], v[106:107]
    v_cvt_pk_bf16_f32 v176, v184, v185
    v_cvt_pk_bf16_f32 v177, v186, v187
    v_cvt_pk_bf16_f32 v178, v188, v189
    v_cvt_pk_bf16_f32 v179, v190, v191
    ds_write_b128 v6, v[176:179] offset:3072
    buffer_store_dwordx4 v[176:179], v2, s[24:27], s49 offen offset:3072 sc1
    v_pk_fma_f32 v[24:25], v[136:137], v[156:157], v[24:25] op_sel_hi:[1,0,1] neg_lo:[0,1,0] neg_hi:[0,1,0]
    v_pk_fma_f32 v[26:27], v[138:139], v[156:157], v[26:27] op_sel_hi:[1,0,1] neg_lo:[0,1,0] neg_hi:[0,1,0]
    v_pk_fma_f32 v[28:29], v[140:141], v[156:157], v[28:29] op_sel_hi:[1,0,1] neg_lo:[0,1,0] neg_hi:[0,1,0]
    v_pk_fma_f32 v[30:31], v[142:143], v[156:157], v[30:31] op_sel_hi:[1,0,1] neg_lo:[0,1,0] neg_hi:[0,1,0]
    v_pk_mul_f32 v[184:185], v[24:25], v[164:165] op_sel_hi:[1,0]
    v_pk_mul_f32 v[186:187], v[26:27], v[164:165] op_sel_hi:[1,0]
    v_pk_mul_f32 v[188:189], v[28:29], v[164:165] op_sel_hi:[1,0]
    v_pk_mul_f32 v[190:191], v[30:31], v[164:165] op_sel_hi:[1,0]
    v_exp_f32 v184, v184
    v_exp_f32 v185, v185
    v_exp_f32 v186, v186
    v_exp_f32 v187, v187
    v_exp_f32 v188, v188
    v_exp_f32 v189, v189
    v_exp_f32 v190, v190
    v_exp_f32 v191, v191
    v_pk_fma_f32 v[184:185], v[184:185], v[156:157], v[156:157] op_sel:[0,1,1] op_sel_hi:[1,1,1]
    v_pk_fma_f32 v[186:187], v[186:187], v[156:157], v[156:157] op_sel:[0,1,1] op_sel_hi:[1,1,1]
    v_pk_fma_f32 v[188:189], v[188:189], v[156:157], v[156:157] op_sel:[0,1,1] op_sel_hi:[1,1,1]
    v_pk_fma_f32 v[190:191], v[190:191], v[156:157], v[156:157] op_sel:[0,1,1] op_sel_hi:[1,1,1]
    v_rcp_f32 v184, v184
    v_rcp_f32 v185, v185
    v_rcp_f32 v186, v186
    v_rcp_f32 v187, v187
    v_rcp_f32 v188, v188
    v_rcp_f32 v189, v189
    v_rcp_f32 v190, v190
    v_rcp_f32 v191, v191
    v_pk_mul_f32 v[184:185], v[184:185], v[24:25]
    v_pk_mul_f32 v[186:187], v[186:187], v[26:27]
    v_pk_mul_f32 v[188:189], v[188:189], v[28:29]
    v_pk_mul_f32 v[190:191], v[190:191], v[30:31]
    v_cvt_pk_bf16_f32 v172, v184, v185
    v_cvt_pk_bf16_f32 v173, v186, v187
    v_cvt_pk_bf16_f32 v174, v188, v189
    v_cvt_pk_bf16_f32 v175, v190, v191
    ds_write_b128 v7, v[172:175] offset:0
    buffer_store_dwordx4 v[172:175], v2, s[24:27], s50 offen offset:0 sc1
    s_barrier
    ds_read_b128 v[192:195], v4 offset:0
    ds_read_b128 v[196:199], v4 offset:1024
    v_pk_fma_f32 v[52:53], v[136:137], v[158:159], v[52:53] op_sel_hi:[1,0,1] neg_lo:[0,1,0] neg_hi:[0,1,0]
    v_pk_fma_f32 v[54:55], v[138:139], v[158:159], v[54:55] op_sel_hi:[1,0,1] neg_lo:[0,1,0] neg_hi:[0,1,0]
    v_pk_fma_f32 v[56:57], v[140:141], v[158:159], v[56:57] op_sel_hi:[1,0,1] neg_lo:[0,1,0] neg_hi:[0,1,0]
    v_pk_fma_f32 v[58:59], v[142:143], v[158:159], v[58:59] op_sel_hi:[1,0,1] neg_lo:[0,1,0] neg_hi:[0,1,0]
    v_pk_mul_f32 v[184:185], v[52:53], v[166:167] op_sel_hi:[1,0]
    v_pk_mul_f32 v[186:187], v[54:55], v[166:167] op_sel_hi:[1,0]
    v_pk_mul_f32 v[188:189], v[56:57], v[166:167] op_sel_hi:[1,0]
    v_pk_mul_f32 v[190:191], v[58:59], v[166:167] op_sel_hi:[1,0]
    v_exp_f32 v184, v184
    v_exp_f32 v185, v185
    v_exp_f32 v186, v186
    v_exp_f32 v187, v187
    v_exp_f32 v188, v188
    v_exp_f32 v189, v189
    v_exp_f32 v190, v190
    v_exp_f32 v191, v191
    v_pk_fma_f32 v[184:185], v[184:185], v[158:159], v[158:159] op_sel:[0,1,1] op_sel_hi:[1,1,1]
    v_pk_fma_f32 v[186:187], v[186:187], v[158:159], v[158:159] op_sel:[0,1,1] op_sel_hi:[1,1,1]
    v_pk_fma_f32 v[188:189], v[188:189], v[158:159], v[158:159] op_sel:[0,1,1] op_sel_hi:[1,1,1]
    v_pk_fma_f32 v[190:191], v[190:191], v[158:159], v[158:159] op_sel:[0,1,1] op_sel_hi:[1,1,1]
    v_rcp_f32 v184, v184
    v_rcp_f32 v185, v185
    v_rcp_f32 v186, v186
    v_rcp_f32 v187, v187
    v_rcp_f32 v188, v188
    v_rcp_f32 v189, v189
    v_rcp_f32 v190, v190
    v_rcp_f32 v191, v191
    v_pk_mul_f32 v[184:185], v[184:185], v[52:53]
    v_pk_mul_f32 v[186:187], v[186:187], v[54:55]
    v_pk_mul_f32 v[188:189], v[188:189], v[56:57]
    v_pk_mul_f32 v[190:191], v[190:191], v[58:59]
    v_cvt_pk_bf16_f32 v176, v184, v185
    v_cvt_pk_bf16_f32 v177, v186, v187
    v_cvt_pk_bf16_f32 v178, v188, v189
    v_cvt_pk_bf16_f32 v179, v190, v191
    ds_write_b128 v7, v[176:179] offset:1024
    buffer_store_dwordx4 v[176:179], v2, s[24:27], s50 offen offset:1024 sc1
    s_waitcnt lgkmcnt(0)
    buffer_store_dwordx4 v[192:195], v2, s[24:27], s52 offen offset:0 sc1
    buffer_store_dwordx4 v[196:199], v2, s[24:27], s52 offen offset:1024 sc1
    v_pk_fma_f32 v[80:81], v[136:137], v[160:161], v[80:81] op_sel_hi:[1,0,1] neg_lo:[0,1,0] neg_hi:[0,1,0]
    v_pk_fma_f32 v[82:83], v[138:139], v[160:161], v[82:83] op_sel_hi:[1,0,1] neg_lo:[0,1,0] neg_hi:[0,1,0]
    v_pk_fma_f32 v[84:85], v[140:141], v[160:161], v[84:85] op_sel_hi:[1,0,1] neg_lo:[0,1,0] neg_hi:[0,1,0]
    v_pk_fma_f32 v[86:87], v[142:143], v[160:161], v[86:87] op_sel_hi:[1,0,1] neg_lo:[0,1,0] neg_hi:[0,1,0]
    v_pk_mul_f32 v[184:185], v[80:81], v[168:169] op_sel_hi:[1,0]
    v_pk_mul_f32 v[186:187], v[82:83], v[168:169] op_sel_hi:[1,0]
    v_pk_mul_f32 v[188:189], v[84:85], v[168:169] op_sel_hi:[1,0]
    v_pk_mul_f32 v[190:191], v[86:87], v[168:169] op_sel_hi:[1,0]
    v_exp_f32 v184, v184
    v_exp_f32 v185, v185
    v_exp_f32 v186, v186
    v_exp_f32 v187, v187
    v_exp_f32 v188, v188
    v_exp_f32 v189, v189
    v_exp_f32 v190, v190
    v_exp_f32 v191, v191
    v_pk_fma_f32 v[184:185], v[184:185], v[160:161], v[160:161] op_sel:[0,1,1] op_sel_hi:[1,1,1]
    v_pk_fma_f32 v[186:187], v[186:187], v[160:161], v[160:161] op_sel:[0,1,1] op_sel_hi:[1,1,1]
    v_pk_fma_f32 v[188:189], v[188:189], v[160:161], v[160:161] op_sel:[0,1,1] op_sel_hi:[1,1,1]
    v_pk_fma_f32 v[190:191], v[190:191], v[160:161], v[160:161] op_sel:[0,1,1] op_sel_hi:[1,1,1]
    v_rcp_f32 v184, v184
    v_rcp_f32 v185, v185
    v_rcp_f32 v186, v186
    v_rcp_f32 v187, v187
    v_rcp_f32 v188, v188
    v_rcp_f32 v189, v189
    v_rcp_f32 v190, v190
    v_rcp_f32 v191, v191
    v_pk_mul_f32 v[184:185], v[184:185], v[80:81]
    v_pk_mul_f32 v[186:187], v[186:187], v[82:83]
    v_pk_mul_f32 v[188:189], v[188:189], v[84:85]
    v_pk_mul_f32 v[190:191], v[190:191], v[86:87]
    v_cvt_pk_bf16_f32 v172, v184, v185
    v_cvt_pk_bf16_f32 v173, v186, v187
    v_cvt_pk_bf16_f32 v174, v188, v189
    v_cvt_pk_bf16_f32 v175, v190, v191
    ds_write_b128 v7, v[172:175] offset:2048
    buffer_store_dwordx4 v[172:175], v2, s[24:27], s50 offen offset:2048 sc1
    v_pk_fma_f32 v[108:109], v[136:137], v[162:163], v[108:109] op_sel_hi:[1,0,1] neg_lo:[0,1,0] neg_hi:[0,1,0]
    v_pk_fma_f32 v[110:111], v[138:139], v[162:163], v[110:111] op_sel_hi:[1,0,1] neg_lo:[0,1,0] neg_hi:[0,1,0]
    v_pk_fma_f32 v[112:113], v[140:141], v[162:163], v[112:113] op_sel_hi:[1,0,1] neg_lo:[0,1,0] neg_hi:[0,1,0]
    v_pk_fma_f32 v[114:115], v[142:143], v[162:163], v[114:115] op_sel_hi:[1,0,1] neg_lo:[0,1,0] neg_hi:[0,1,0]
    v_pk_mul_f32 v[184:185], v[108:109], v[170:171] op_sel_hi:[1,0]
    v_pk_mul_f32 v[186:187], v[110:111], v[170:171] op_sel_hi:[1,0]
    v_pk_mul_f32 v[188:189], v[112:113], v[170:171] op_sel_hi:[1,0]
    v_pk_mul_f32 v[190:191], v[114:115], v[170:171] op_sel_hi:[1,0]
    v_exp_f32 v184, v184
    v_exp_f32 v185, v185
    v_exp_f32 v186, v186
    v_exp_f32 v187, v187
    v_exp_f32 v188, v188
    v_exp_f32 v189, v189
    v_exp_f32 v190, v190
    v_exp_f32 v191, v191
    v_pk_fma_f32 v[184:185], v[184:185], v[162:163], v[162:163] op_sel:[0,1,1] op_sel_hi:[1,1,1]
    v_pk_fma_f32 v[186:187], v[186:187], v[162:163], v[162:163] op_sel:[0,1,1] op_sel_hi:[1,1,1]
    v_pk_fma_f32 v[188:189], v[188:189], v[162:163], v[162:163] op_sel:[0,1,1] op_sel_hi:[1,1,1]
    v_pk_fma_f32 v[190:191], v[190:191], v[162:163], v[162:163] op_sel:[0,1,1] op_sel_hi:[1,1,1]
    v_rcp_f32 v184, v184
    v_rcp_f32 v185, v185
    v_rcp_f32 v186, v186
    v_rcp_f32 v187, v187
    v_rcp_f32 v188, v188
    v_rcp_f32 v189, v189
    v_rcp_f32 v190, v190
    v_rcp_f32 v191, v191
    v_pk_mul_f32 v[184:185], v[184:185], v[108:109]
    v_pk_mul_f32 v[186:187], v[186:187], v[110:111]
    v_pk_mul_f32 v[188:189], v[188:189], v[112:113]
    v_pk_mul_f32 v[190:191], v[190:191], v[114:115]
    v_cvt_pk_bf16_f32 v176, v184, v185
    v_cvt_pk_bf16_f32 v177, v186, v187
    v_cvt_pk_bf16_f32 v178, v188, v189
    v_cvt_pk_bf16_f32 v179, v190, v191
    ds_write_b128 v7, v[176:179] offset:3072
    buffer_store_dwordx4 v[176:179], v2, s[24:27], s50 offen offset:3072 sc1
    v_pk_fma_f32 v[32:33], v[144:145], v[156:157], v[32:33] op_sel_hi:[1,0,1] neg_lo:[0,1,0] neg_hi:[0,1,0]
    v_pk_fma_f32 v[34:35], v[146:147], v[156:157], v[34:35] op_sel_hi:[1,0,1] neg_lo:[0,1,0] neg_hi:[0,1,0]
    v_pk_fma_f32 v[36:37], v[148:149], v[156:157], v[36:37] op_sel_hi:[1,0,1] neg_lo:[0,1,0] neg_hi:[0,1,0]
    v_pk_fma_f32 v[38:39], v[150:151], v[156:157], v[38:39] op_sel_hi:[1,0,1] neg_lo:[0,1,0] neg_hi:[0,1,0]
    v_pk_mul_f32 v[184:185], v[32:33], v[164:165] op_sel_hi:[1,0]
    v_pk_mul_f32 v[186:187], v[34:35], v[164:165] op_sel_hi:[1,0]
    v_pk_mul_f32 v[188:189], v[36:37], v[164:165] op_sel_hi:[1,0]
    v_pk_mul_f32 v[190:191], v[38:39], v[164:165] op_sel_hi:[1,0]
    v_exp_f32 v184, v184
    v_exp_f32 v185, v185
    v_exp_f32 v186, v186
    v_exp_f32 v187, v187
    v_exp_f32 v188, v188
    v_exp_f32 v189, v189
    v_exp_f32 v190, v190
    v_exp_f32 v191, v191
    v_pk_fma_f32 v[184:185], v[184:185], v[156:157], v[156:157] op_sel:[0,1,1] op_sel_hi:[1,1,1]
    v_pk_fma_f32 v[186:187], v[186:187], v[156:157], v[156:157] op_sel:[0,1,1] op_sel_hi:[1,1,1]
    v_pk_fma_f32 v[188:189], v[188:189], v[156:157], v[156:157] op_sel:[0,1,1] op_sel_hi:[1,1,1]
    v_pk_fma_f32 v[190:191], v[190:191], v[156:157], v[156:157] op_sel:[0,1,1] op_sel_hi:[1,1,1]
    v_rcp_f32 v184, v184
    v_rcp_f32 v185, v185
    v_rcp_f32 v186, v186
    v_rcp_f32 v187, v187
    v_rcp_f32 v188, v188
    v_rcp_f32 v189, v189
    v_rcp_f32 v190, v190
    v_rcp_f32 v191, v191
    v_pk_mul_f32 v[184:185], v[184:185], v[32:33]
    v_pk_mul_f32 v[186:187], v[186:187], v[34:35]
    v_pk_mul_f32 v[188:189], v[188:189], v[36:37]
    v_pk_mul_f32 v[190:191], v[190:191], v[38:39]
    v_cvt_pk_bf16_f32 v172, v184, v185
    v_cvt_pk_bf16_f32 v173, v186, v187
    v_cvt_pk_bf16_f32 v174, v188, v189
    v_cvt_pk_bf16_f32 v175, v190, v191
    ds_write_b128 v6, v[172:175] offset:32768
    buffer_store_dwordx4 v[172:175], v2, s[24:27], s51 offen offset:0 sc1
    v_pk_fma_f32 v[60:61], v[144:145], v[158:159], v[60:61] op_sel_hi:[1,0,1] neg_lo:[0,1,0] neg_hi:[0,1,0]
    v_pk_fma_f32 v[62:63], v[146:147], v[158:159], v[62:63] op_sel_hi:[1,0,1] neg_lo:[0,1,0] neg_hi:[0,1,0]
    v_pk_fma_f32 v[64:65], v[148:149], v[158:159], v[64:65] op_sel_hi:[1,0,1] neg_lo:[0,1,0] neg_hi:[0,1,0]
    v_pk_fma_f32 v[66:67], v[150:151], v[158:159], v[66:67] op_sel_hi:[1,0,1] neg_lo:[0,1,0] neg_hi:[0,1,0]
    v_pk_mul_f32 v[184:185], v[60:61], v[166:167] op_sel_hi:[1,0]
    v_pk_mul_f32 v[186:187], v[62:63], v[166:167] op_sel_hi:[1,0]
    v_pk_mul_f32 v[188:189], v[64:65], v[166:167] op_sel_hi:[1,0]
    v_pk_mul_f32 v[190:191], v[66:67], v[166:167] op_sel_hi:[1,0]
    v_exp_f32 v184, v184
    v_exp_f32 v185, v185
    v_exp_f32 v186, v186
    v_exp_f32 v187, v187
    v_exp_f32 v188, v188
    v_exp_f32 v189, v189
    v_exp_f32 v190, v190
    v_exp_f32 v191, v191
    v_pk_fma_f32 v[184:185], v[184:185], v[158:159], v[158:159] op_sel:[0,1,1] op_sel_hi:[1,1,1]
    v_pk_fma_f32 v[186:187], v[186:187], v[158:159], v[158:159] op_sel:[0,1,1] op_sel_hi:[1,1,1]
    v_pk_fma_f32 v[188:189], v[188:189], v[158:159], v[158:159] op_sel:[0,1,1] op_sel_hi:[1,1,1]
    v_pk_fma_f32 v[190:191], v[190:191], v[158:159], v[158:159] op_sel:[0,1,1] op_sel_hi:[1,1,1]
    v_rcp_f32 v184, v184
    v_rcp_f32 v185, v185
    v_rcp_f32 v186, v186
    v_rcp_f32 v187, v187
    v_rcp_f32 v188, v188
    v_rcp_f32 v189, v189
    v_rcp_f32 v190, v190
    v_rcp_f32 v191, v191
    v_pk_mul_f32 v[184:185], v[184:185], v[60:61]
    v_pk_mul_f32 v[186:187], v[186:187], v[62:63]
    v_pk_mul_f32 v[188:189], v[188:189], v[64:65]
    v_pk_mul_f32 v[190:191], v[190:191], v[66:67]
    v_cvt_pk_bf16_f32 v176, v184, v185
    v_cvt_pk_bf16_f32 v177, v186, v187
    v_cvt_pk_bf16_f32 v178, v188, v189
    v_cvt_pk_bf16_f32 v179, v190, v191
    ds_write_b128 v6, v[176:179] offset:33792
    buffer_store_dwordx4 v[176:179], v2, s[24:27], s51 offen offset:1024 sc1
    v_pk_fma_f32 v[88:89], v[144:145], v[160:161], v[88:89] op_sel_hi:[1,0,1] neg_lo:[0,1,0] neg_hi:[0,1,0]
    v_pk_fma_f32 v[90:91], v[146:147], v[160:161], v[90:91] op_sel_hi:[1,0,1] neg_lo:[0,1,0] neg_hi:[0,1,0]
    v_pk_fma_f32 v[92:93], v[148:149], v[160:161], v[92:93] op_sel_hi:[1,0,1] neg_lo:[0,1,0] neg_hi:[0,1,0]
    v_pk_fma_f32 v[94:95], v[150:151], v[160:161], v[94:95] op_sel_hi:[1,0,1] neg_lo:[0,1,0] neg_hi:[0,1,0]
    v_pk_mul_f32 v[184:185], v[88:89], v[168:169] op_sel_hi:[1,0]
    v_pk_mul_f32 v[186:187], v[90:91], v[168:169] op_sel_hi:[1,0]
    v_pk_mul_f32 v[188:189], v[92:93], v[168:169] op_sel_hi:[1,0]
    v_pk_mul_f32 v[190:191], v[94:95], v[168:169] op_sel_hi:[1,0]
    v_exp_f32 v184, v184
    v_exp_f32 v185, v185
    v_exp_f32 v186, v186
    v_exp_f32 v187, v187
    v_exp_f32 v188, v188
    v_exp_f32 v189, v189
    v_exp_f32 v190, v190
    v_exp_f32 v191, v191
    v_pk_fma_f32 v[184:185], v[184:185], v[160:161], v[160:161] op_sel:[0,1,1] op_sel_hi:[1,1,1]
    v_pk_fma_f32 v[186:187], v[186:187], v[160:161], v[160:161] op_sel:[0,1,1] op_sel_hi:[1,1,1]
    v_pk_fma_f32 v[188:189], v[188:189], v[160:161], v[160:161] op_sel:[0,1,1] op_sel_hi:[1,1,1]
    v_pk_fma_f32 v[190:191], v[190:191], v[160:161], v[160:161] op_sel:[0,1,1] op_sel_hi:[1,1,1]
    v_rcp_f32 v184, v184
    v_rcp_f32 v185, v185
    v_rcp_f32 v186, v186
    v_rcp_f32 v187, v187
    v_rcp_f32 v188, v188
    v_rcp_f32 v189, v189
    v_rcp_f32 v190, v190
    v_rcp_f32 v191, v191
    v_pk_mul_f32 v[184:185], v[184:185], v[88:89]
    v_pk_mul_f32 v[186:187], v[186:187], v[90:91]
    v_pk_mul_f32 v[188:189], v[188:189], v[92:93]
    v_pk_mul_f32 v[190:191], v[190:191], v[94:95]
    v_cvt_pk_bf16_f32 v172, v184, v185
    v_cvt_pk_bf16_f32 v173, v186, v187
    v_cvt_pk_bf16_f32 v174, v188, v189
    v_cvt_pk_bf16_f32 v175, v190, v191
    ds_write_b128 v6, v[172:175] offset:34816
    buffer_store_dwordx4 v[172:175], v2, s[24:27], s51 offen offset:2048 sc1
    v_pk_fma_f32 v[116:117], v[144:145], v[162:163], v[116:117] op_sel_hi:[1,0,1] neg_lo:[0,1,0] neg_hi:[0,1,0]
    v_pk_fma_f32 v[118:119], v[146:147], v[162:163], v[118:119] op_sel_hi:[1,0,1] neg_lo:[0,1,0] neg_hi:[0,1,0]
    v_pk_fma_f32 v[120:121], v[148:149], v[162:163], v[120:121] op_sel_hi:[1,0,1] neg_lo:[0,1,0] neg_hi:[0,1,0]
    v_pk_fma_f32 v[122:123], v[150:151], v[162:163], v[122:123] op_sel_hi:[1,0,1] neg_lo:[0,1,0] neg_hi:[0,1,0]
    v_pk_mul_f32 v[184:185], v[116:117], v[170:171] op_sel_hi:[1,0]
    v_pk_mul_f32 v[186:187], v[118:119], v[170:171] op_sel_hi:[1,0]
    v_pk_mul_f32 v[188:189], v[120:121], v[170:171] op_sel_hi:[1,0]
    v_pk_mul_f32 v[190:191], v[122:123], v[170:171] op_sel_hi:[1,0]
    v_exp_f32 v184, v184
    v_exp_f32 v185, v185
    v_exp_f32 v186, v186
    v_exp_f32 v187, v187
    v_exp_f32 v188, v188
    v_exp_f32 v189, v189
    v_exp_f32 v190, v190
    v_exp_f32 v191, v191
    v_pk_fma_f32 v[184:185], v[184:185], v[162:163], v[162:163] op_sel:[0,1,1] op_sel_hi:[1,1,1]
    v_pk_fma_f32 v[186:187], v[186:187], v[162:163], v[162:163] op_sel:[0,1,1] op_sel_hi:[1,1,1]
    v_pk_fma_f32 v[188:189], v[188:189], v[162:163], v[162:163] op_sel:[0,1,1] op_sel_hi:[1,1,1]
    v_pk_fma_f32 v[190:191], v[190:191], v[162:163], v[162:163] op_sel:[0,1,1] op_sel_hi:[1,1,1]
    v_rcp_f32 v184, v184
    v_rcp_f32 v185, v185
    v_rcp_f32 v186, v186
    v_rcp_f32 v187, v187
    v_rcp_f32 v188, v188
    v_rcp_f32 v189, v189
    v_rcp_f32 v190, v190
    v_rcp_f32 v191, v191
    v_pk_mul_f32 v[184:185], v[184:185], v[116:117]
    v_pk_mul_f32 v[186:187], v[186:187], v[118:119]
    v_pk_mul_f32 v[188:189], v[188:189], v[120:121]
    v_pk_mul_f32 v[190:191], v[190:191], v[122:123]
    v_cvt_pk_bf16_f32 v176, v184, v185
    v_cvt_pk_bf16_f32 v177, v186, v187
    v_cvt_pk_bf16_f32 v178, v188, v189
    v_cvt_pk_bf16_f32 v179, v190, v191
    ds_write_b128 v6, v[176:179] offset:35840
    buffer_store_dwordx4 v[176:179], v2, s[24:27], s51 offen offset:3072 sc1
    s_branch L_epi_ret_c
L_consumer:
    s_lshl_b32 s48, s46, 12
    s_add_u32 s48, s48, 90112
    v_add_u32 v10, s48, v240
    s_setprio 2
    s_waitcnt lgkmcnt(0)
    s_barrier
    ds_read_b128 v[128:131], v6 offset:0
    ds_read_b64_tr_b16 v[144:145], v7 offset:0
    ds_read_b64_tr_b16 v[146:147], v7 offset:7168
    ds_read_b64_tr_b16 v[148:149], v8 offset:32
    ds_read_b64_tr_b16 v[150:151], v8 offset:7200
    ds_read_b128 v[132:135], v6 offset:2048
    ds_read_b64_tr_b16 v[152:153], v7 offset:64
    ds_read_b64_tr_b16 v[154:155], v7 offset:7232
    ds_read_b64_tr_b16 v[156:157], v8 offset:96
    ds_read_b64_tr_b16 v[158:159], v8 offset:7264
    ds_read_b128 v[136:139], v6 offset:4096
    ds_read_b64_tr_b16 v[160:161], v7 offset:128
    ds_read_b64_tr_b16 v[162:163], v7 offset:7296
    ds_read_b64_tr_b16 v[164:165], v8 offset:160
    ds_read_b64_tr_b16 v[166:167], v8 offset:7328
    ds_read_b128 v[140:143], v6 offset:6144
    ds_read_b64_tr_b16 v[168:169], v9 offset:0
    ds_read_b64_tr_b16 v[170:171], v9 offset:7168
    s_mov_b32 s86, 0
    s_waitcnt lgkmcnt(0)
    v_mfma_f32_16x16x32_bf16 v[16:19], v[144:147], v[128:131], 0
    ds_read_b128 v[172:175], v14 offset:0
    v_mfma_f32_16x16x32_bf16 v[20:23], v[148:151], v[128:131], 0
    ds_read_b64_tr_b16 v[188:189], v7 offset:14336
    v_mfma_f32_16x16x32_bf16 v[24:27], v[152:155], v[128:131], 0
    ds_read_b64_tr_b16 v[190:191], v7 offset:21504
    v_mfma_f32_16x16x32_bf16 v[28:31], v[156:159], v[128:131], 0
    ds_read_b64_tr_b16 v[192:193], v8 offset:14368
    v_mfma_f32_16x16x32_bf16 v[32:35], v[160:163], v[128:131], 0
    ds_read_b64_tr_b16 v[194:195], v8 offset:21536
    v_mfma_f32_16x16x32_bf16 v[36:39], v[164:167], v[128:131], 0
    ds_read_b128 v[176:179], v14 offset:2048
    v_mfma_f32_16x16x32_bf16 v[40:43], v[168:171], v[128:131], 0
    ds_read_b64_tr_b16 v[196:197], v7 offset:14400
    v_mfma_f32_16x16x32_bf16 v[44:47], v[144:147], v[132:135], 0
    ds_read_b64_tr_b16 v[198:199], v7 offset:21568
    v_mfma_f32_16x16x32_bf16 v[48:51], v[148:151], v[132:135], 0
    ds_read_b64_tr_b16 v[200:201], v8 offset:14432
    v_mfma_f32_16x16x32_bf16 v[52:55], v[152:155], v[132:135], 0
    ds_read_b64_tr_b16 v[202:203], v8 offset:21600
    v_mfma_f32_16x16x32_bf16 v[56:59], v[156:159], v[132:135], 0
    ds_read_b128 v[180:183], v14 offset:4096
    v_mfma_f32_16x16x32_bf16 v[60:63], v[160:163], v[132:135], 0
    ds_read_b64_tr_b16 v[204:205], v7 offset:14464
    v_mfma_f32_16x16x32_bf16 v[64:67], v[164:167], v[132:135], 0
    ds_read_b64_tr_b16 v[206:207], v7 offset:21632
    v_mfma_f32_16x16x32_bf16 v[68:71], v[168:171], v[132:135], 0
    ds_read_b64_tr_b16 v[208:209], v8 offset:14496
    v_mfma_f32_16x16x32_bf16 v[72:75], v[144:147], v[136:139], 0
    ds_read_b64_tr_b16 v[210:211], v8 offset:21664
    v_mfma_f32_16x16x32_bf16 v[76:79], v[148:151], v[136:139], 0
    ds_read_b128 v[184:187], v14 offset:6144
    v_mfma_f32_16x16x32_bf16 v[80:83], v[152:155], v[136:139], 0
    ds_read_b64_tr_b16 v[212:213], v9 offset:14336
    v_mfma_f32_16x16x32_bf16 v[84:87], v[156:159], v[136:139], 0
    ds_read_b64_tr_b16 v[214:215], v9 offset:21504
    v_mfma_f32_16x16x32_bf16 v[88:91], v[160:163], v[136:139], 0
    s_add_u32 s47, s47, 45056
    v_mfma_f32_16x16x32_bf16 v[92:95], v[164:167], v[136:139], 0
    s_cmp_eq_u32 s47, 135168
    v_mfma_f32_16x16x32_bf16 v[96:99], v[168:171], v[136:139], 0
    s_cselect_b32 s47, 0, s47
    v_mfma_f32_16x16x32_bf16 v[100:103], v[144:147], v[140:143], 0
    v_add_u32 v6, s47, v2
    v_mfma_f32_16x16x32_bf16 v[104:107], v[148:151], v[140:143], 0
    v_add_u32 v7, s47, v3
    v_mfma_f32_16x16x32_bf16 v[108:111], v[152:155], v[140:143], 0
    v_add_u32 v8, s47, v4
    v_mfma_f32_16x16x32_bf16 v[112:115], v[156:159], v[140:143], 0
    v_add_u32 v9, s47, v5
    v_mfma_f32_16x16x32_bf16 v[116:119], v[160:163], v[140:143], 0
    v_add_u32 v14, s47, v15
    v_mfma_f32_16x16x32_bf16 v[120:123], v[164:167], v[140:143], 0
    v_mfma_f32_16x16x32_bf16 v[124:127], v[168:171], v[140:143], 0
    s_branch L_c_g1mid
L_c_g1loop:
    s_waitcnt lgkmcnt(0)
    v_mfma_f32_16x16x32_bf16 v[16:19], v[144:147], v[128:131], v[16:19]
    ds_read_b128 v[172:175], v14 offset:0
    v_mfma_f32_16x16x32_bf16 v[20:23], v[148:151], v[128:131], v[20:23]
    ds_read_b64_tr_b16 v[188:189], v7 offset:14336
    v_mfma_f32_16x16x32_bf16 v[24:27], v[152:155], v[128:131], v[24:27]
    ds_read_b64_tr_b16 v[190:191], v7 offset:21504
    v_mfma_f32_16x16x32_bf16 v[28:31], v[156:159], v[128:131], v[28:31]
    ds_read_b64_tr_b16 v[192:193], v8 offset:14368
    v_mfma_f32_16x16x32_bf16 v[32:35], v[160:163], v[128:131], v[32:35]
    ds_read_b64_tr_b16 v[194:195], v8 offset:21536
    v_mfma_f32_16x16x32_bf16 v[36:39], v[164:167], v[128:131], v[36:39]
    ds_read_b128 v[176:179], v14 offset:2048
    v_mfma_f32_16x16x32_bf16 v[40:43], v[168:171], v[128:131], v[40:43]
    ds_read_b64_tr_b16 v[196:197], v7 offset:14400
    v_mfma_f32_16x16x32_bf16 v[44:47], v[144:147], v[132:135], v[44:47]
    ds_read_b64_tr_b16 v[198:199], v7 offset:21568
    v_mfma_f32_16x16x32_bf16 v[48:51], v[148:151], v[132:135], v[48:51]
    ds_read_b64_tr_b16 v[200:201], v8 offset:14432
    v_mfma_f32_16x16x32_bf16 v[52:55], v[152:155], v[132:135], v[52:55]
    ds_read_b64_tr_b16 v[202:203], v8 offset:21600
    v_mfma_f32_16x16x32_bf16 v[56:59], v[156:159], v[132:135], v[56:59]
    ds_read_b128 v[180:183], v14 offset:4096
    v_mfma_f32_16x16x32_bf16 v[60:63], v[160:163], v[132:135], v[60:63]
    ds_read_b64_tr_b16 v[204:205], v7 offset:14464
    v_mfma_f32_16x16x32_bf16 v[64:67], v[164:167], v[132:135], v[64:67]
    ds_read_b64_tr_b16 v[206:207], v7 offset:21632
    v_mfma_f32_16x16x32_bf16 v[68:71], v[168:171], v[132:135], v[68:71]
    ds_read_b64_tr_b16 v[208:209], v8 offset:14496
    v_mfma_f32_16x16x32_bf16 v[72:75], v[144:147], v[136:139], v[72:75]
    ds_read_b64_tr_b16 v[210:211], v8 offset:21664
    v_mfma_f32_16x16x32_bf16 v[76:79], v[148:151], v[136:139], v[76:79]
    ds_read_b128 v[184:187], v14 offset:6144
    v_mfma_f32_16x16x32_bf16 v[80:83], v[152:155], v[136:139], v[80:83]
    ds_read_b64_tr_b16 v[212:213], v9 offset:14336
    v_mfma_f32_16x16x32_bf16 v[84:87], v[156:159], v[136:139], v[84:87]
    ds_read_b64_tr_b16 v[214:215], v9 offset:21504
    v_mfma_f32_16x16x32_bf16 v[88:91], v[160:163], v[136:139], v[88:91]
    s_add_u32 s47, s47, 45056
    v_mfma_f32_16x16x32_bf16 v[92:95], v[164:167], v[136:139], v[92:95]
    s_cmp_eq_u32 s47, 135168
    v_mfma_f32_16x16x32_bf16 v[96:99], v[168:171], v[136:139], v[96:99]
    s_cselect_b32 s47, 0, s47
    v_mfma_f32_16x16x32_bf16 v[100:103], v[144:147], v[140:143], v[100:103]
    v_add_u32 v6, s47, v2
    v_mfma_f32_16x16x32_bf16 v[104:107], v[148:151], v[140:143], v[104:107]
    v_add_u32 v7, s47, v3
    v_mfma_f32_16x16x32_bf16 v[108:111], v[152:155], v[140:143], v[108:111]
    v_add_u32 v8, s47, v4
    v_mfma_f32_16x16x32_bf16 v[112:115], v[156:159], v[140:143], v[112:115]
    v_add_u32 v9, s47, v5
    v_mfma_f32_16x16x32_bf16 v[116:119], v[160:163], v[140:143], v[116:119]
    v_add_u32 v14, s47, v15
    v_mfma_f32_16x16x32_bf16 v[120:123], v[164:167], v[140:143], v[120:123]
    v_mfma_f32_16x16x32_bf16 v[124:127], v[168:171], v[140:143], v[124:127]
L_c_g1mid:
    s_waitcnt lgkmcnt(0)
    s_cmp_eq_u32 s95, s94
    s_barrier
    s_cbranch_scc1 L_cs0
L_csr0:
    v_mfma_f32_16x16x32_bf16 v[16:19], v[188:191], v[172:175], v[16:19]
    ds_read_b128 v[128:131], v6 offset:0
    v_mfma_f32_16x16x32_bf16 v[20:23], v[192:195], v[172:175], v[20:23]
    ds_read_b64_tr_b16 v[144:145], v7 offset:0
    v_mfma_f32_16x16x32_bf16 v[24:27], v[196:199], v[172:175], v[24:27]
    ds_read_b64_tr_b16 v[146:147], v7 offset:7168
    v_mfma_f32_16x16x32_bf16 v[28:31], v[200:203], v[172:175], v[28:31]
    ds_read_b64_tr_b16 v[148:149], v8 offset:32
    v_mfma_f32_16x16x32_bf16 v[32:35], v[204:207], v[172:175], v[32:35]
    ds_read_b64_tr_b16 v[150:151], v8 offset:7200
    v_mfma_f32_16x16x32_bf16 v[36:39], v[208:211], v[172:175], v[36:39]
    ds_read_b128 v[132:135], v6 offset:2048
    v_mfma_f32_16x16x32_bf16 v[40:43], v[212:215], v[172:175], v[40:43]
    ds_read_b64_tr_b16 v[152:153], v7 offset:64
    v_mfma_f32_16x16x32_bf16 v[44:47], v[188:191], v[176:179], v[44:47]
    ds_read_b64_tr_b16 v[154:155], v7 offset:7232
    v_mfma_f32_16x16x32_bf16 v[48:51], v[192:195], v[176:179], v[48:51]
    ds_read_b64_tr_b16 v[156:157], v8 offset:96
    v_mfma_f32_16x16x32_bf16 v[52:55], v[196:199], v[176:179], v[52:55]
    ds_read_b64_tr_b16 v[158:159], v8 offset:7264
    v_mfma_f32_16x16x32_bf16 v[56:59], v[200:203], v[176:179], v[56:59]
    ds_read_b128 v[136:139], v6 offset:4096
    v_mfma_f32_16x16x32_bf16 v[60:63], v[204:207], v[176:179], v[60:63]
    ds_read_b64_tr_b16 v[160:161], v7 offset:128
    v_mfma_f32_16x16x32_bf16 v[64:67], v[208:211], v[176:179], v[64:67]
    ds_read_b64_tr_b16 v[162:163], v7 offset:7296
    v_mfma_f32_16x16x32_bf16 v[68:71], v[212:215], v[176:179], v[68:71]
    ds_read_b64_tr_b16 v[164:165], v8 offset:160
    v_mfma_f32_16x16x32_bf16 v[72:75], v[188:191], v[180:183], v[72:75]
    ds_read_b64_tr_b16 v[166:167], v8 offset:7328
    v_mfma_f32_16x16x32_bf16 v[76:79], v[192:195], v[180:183], v[76:79]
    ds_read_b128 v[140:143], v6 offset:6144
    v_mfma_f32_16x16x32_bf16 v[80:83], v[196:199], v[180:183], v[80:83]
    ds_read_b64_tr_b16 v[168:169], v9 offset:0
    v_mfma_f32_16x16x32_bf16 v[84:87], v[200:203], v[180:183], v[84:87]
    ds_read_b64_tr_b16 v[170:171], v9 offset:7168
    v_mfma_f32_16x16x32_bf16 v[88:91], v[204:207], v[180:183], v[88:91]
    s_add_u32 s95, s95, 1
    v_mfma_f32_16x16x32_bf16 v[92:95], v[208:211], v[180:183], v[92:95]
    v_mfma_f32_16x16x32_bf16 v[96:99], v[212:215], v[180:183], v[96:99]
    v_mfma_f32_16x16x32_bf16 v[100:103], v[188:191], v[184:187], v[100:103]
    v_mfma_f32_16x16x32_bf16 v[104:107], v[192:195], v[184:187], v[104:107]
    v_mfma_f32_16x16x32_bf16 v[108:111], v[196:199], v[184:187], v[108:111]
    v_mfma_f32_16x16x32_bf16 v[112:115], v[200:203], v[184:187], v[112:115]
    v_mfma_f32_16x16x32_bf16 v[116:119], v[204:207], v[184:187], v[116:119]
    v_mfma_f32_16x16x32_bf16 v[120:123], v[208:211], v[184:187], v[120:123]
    v_mfma_f32_16x16x32_bf16 v[124:127], v[212:215], v[184:187], v[124:127]
    s_waitcnt lgkmcnt(0)
    v_mfma_f32_16x16x32_bf16 v[16:19], v[144:147], v[128:131], v[16:19]
    ds_read_b128 v[172:175], v14 offset:0
    v_mfma_f32_16x16x32_bf16 v[20:23], v[148:151], v[128:131], v[20:23]
    ds_read_b64_tr_b16 v[188:189], v7 offset:14336
    v_mfma_f32_16x16x32_bf16 v[24:27], v[152:155], v[128:131], v[24:27]
    ds_read_b64_tr_b16 v[190:191], v7 offset:21504
    v_mfma_f32_16x16x32_bf16 v[28:31], v[156:159], v[128:131], v[28:31]
    ds_read_b64_tr_b16 v[192:193], v8 offset:14368
    v_mfma_f32_16x16x32_bf16 v[32:35], v[160:163], v[128:131], v[32:35]
    ds_read_b64_tr_b16 v[194:195], v8 offset:21536
    v_mfma_f32_16x16x32_bf16 v[36:39], v[164:167], v[128:131], v[36:39]
    ds_read_b128 v[176:179], v14 offset:2048
    v_mfma_f32_16x16x32_bf16 v[40:43], v[168:171], v[128:131], v[40:43]
    ds_read_b64_tr_b16 v[196:197], v7 offset:14400
    v_mfma_f32_16x16x32_bf16 v[44:47], v[144:147], v[132:135], v[44:47]
    ds_read_b64_tr_b16 v[198:199], v7 offset:21568
    v_mfma_f32_16x16x32_bf16 v[48:51], v[148:151], v[132:135], v[48:51]
    ds_read_b64_tr_b16 v[200:201], v8 offset:14432
    v_mfma_f32_16x16x32_bf16 v[52:55], v[152:155], v[132:135], v[52:55]
    ds_read_b64_tr_b16 v[202:203], v8 offset:21600
    v_mfma_f32_16x16x32_bf16 v[56:59], v[156:159], v[132:135], v[56:59]
    ds_read_b128 v[180:183], v14 offset:4096
    v_mfma_f32_16x16x32_bf16 v[60:63], v[160:163], v[132:135], v[60:63]
    ds_read_b64_tr_b16 v[204:205], v7 offset:14464
    v_mfma_f32_16x16x32_bf16 v[64:67], v[164:167], v[132:135], v[64:67]
    ds_read_b64_tr_b16 v[206:207], v7 offset:21632
    v_mfma_f32_16x16x32_bf16 v[68:71], v[168:171], v[132:135], v[68:71]
    ds_read_b64_tr_b16 v[208:209], v8 offset:14496
    v_mfma_f32_16x16x32_bf16 v[72:75], v[144:147], v[136:139], v[72:75]
    ds_read_b64_tr_b16 v[210:211], v8 offset:21664
    v_mfma_f32_16x16x32_bf16 v[76:79], v[148:151], v[136:139], v[76:79]
    ds_read_b128 v[184:187], v14 offset:6144
    v_mfma_f32_16x16x32_bf16 v[80:83], v[152:155], v[136:139], v[80:83]
    ds_read_b64_tr_b16 v[212:213], v9 offset:14336
    v_mfma_f32_16x16x32_bf16 v[84:87], v[156:159], v[136:139], v[84:87]
    ds_read_b64_tr_b16 v[214:215], v9 offset:21504
    v_mfma_f32_16x16x32_bf16 v[88:91], v[160:163], v[136:139], v[88:91]
    s_add_u32 s47, s47, 45056
    v_mfma_f32_16x16x32_bf16 v[92:95], v[164:167], v[136:139], v[92:95]
    s_cmp_eq_u32 s47, 135168
    v_mfma_f32_16x16x32_bf16 v[96:99], v[168:171], v[136:139], v[96:99]
    s_cselect_b32 s47, 0, s47
    v_mfma_f32_16x16x32_bf16 v[100:103], v[144:147], v[140:143], v[100:103]
    v_add_u32 v6, s47, v2
    v_mfma_f32_16x16x32_bf16 v[104:107], v[148:151], v[140:143], v[104:107]
    v_add_u32 v7, s47, v3
    v_mfma_f32_16x16x32_bf16 v[108:111], v[152:155], v[140:143], v[108:111]
    v_add_u32 v8, s47, v4
    v_mfma_f32_16x16x32_bf16 v[112:115], v[156:159], v[140:143], v[112:115]
    v_add_u32 v9, s47, v5
    v_mfma_f32_16x16x32_bf16 v[116:119], v[160:163], v[140:143], v[116:119]
    v_add_u32 v14, s47, v15
    v_mfma_f32_16x16x32_bf16 v[120:123], v[164:167], v[140:143], v[120:123]
    v_mfma_f32_16x16x32_bf16 v[124:127], v[168:171], v[140:143], v[124:127]
    s_waitcnt lgkmcnt(0)
    s_cmp_eq_u32 s95, s94
    s_barrier
    s_cbranch_scc1 L_cs1
L_csr1:
    v_mfma_f32_16x16x32_bf16 v[16:19], v[188:191], v[172:175], v[16:19]
    ds_read_b128 v[128:131], v6 offset:0
    v_mfma_f32_16x16x32_bf16 v[20:23], v[192:195], v[172:175], v[20:23]
    ds_read_b64_tr_b16 v[144:145], v7 offset:0
    v_mfma_f32_16x16x32_bf16 v[24:27], v[196:199], v[172:175], v[24:27]
    ds_read_b64_tr_b16 v[146:147], v7 offset:7168
    v_mfma_f32_16x16x32_bf16 v[28:31], v[200:203], v[172:175], v[28:31]
    ds_read_b64_tr_b16 v[148:149], v8 offset:32
    v_mfma_f32_16x16x32_bf16 v[32:35], v[204:207], v[172:175], v[32:35]
    ds_read_b64_tr_b16 v[150:151], v8 offset:7200
    v_mfma_f32_16x16x32_bf16 v[36:39], v[208:211], v[172:175], v[36:39]
    ds_read_b128 v[132:135], v6 offset:2048
    v_mfma_f32_16x16x32_bf16 v[40:43], v[212:215], v[172:175], v[40:43]
    ds_read_b64_tr_b16 v[152:153], v7 offset:64
    v_mfma_f32_16x16x32_bf16 v[44:47], v[188:191], v[176:179], v[44:47]
    ds_read_b64_tr_b16 v[154:155], v7 offset:7232
    v_mfma_f32_16x16x32_bf16 v[48:51], v[192:195], v[176:179], v[48:51]
    ds_read_b64_tr_b16 v[156:157], v8 offset:96
    v_mfma_f32_16x16x32_bf16 v[52:55], v[196:199], v[176:179], v[52:55]
    ds_read_b64_tr_b16 v[158:159], v8 offset:7264
    v_mfma_f32_16x16x32_bf16 v[56:59], v[200:203], v[176:179], v[56:59]
    ds_read_b128 v[136:139], v6 offset:4096
    v_mfma_f32_16x16x32_bf16 v[60:63], v[204:207], v[176:179], v[60:63]
    ds_read_b64_tr_b16 v[160:161], v7 offset:128
    v_mfma_f32_16x16x32_bf16 v[64:67], v[208:211], v[176:179], v[64:67]
    ds_read_b64_tr_b16 v[162:163], v7 offset:7296
    v_mfma_f32_16x16x32_bf16 v[68:71], v[212:215], v[176:179], v[68:71]
    ds_read_b64_tr_b16 v[164:165], v8 offset:160
    v_mfma_f32_16x16x32_bf16 v[72:75], v[188:191], v[180:183], v[72:75]
    ds_read_b64_tr_b16 v[166:167], v8 offset:7328
    v_mfma_f32_16x16x32_bf16 v[76:79], v[192:195], v[180:183], v[76:79]
    ds_read_b128 v[140:143], v6 offset:6144
    v_mfma_f32_16x16x32_bf16 v[80:83], v[196:199], v[180:183], v[80:83]
    ds_read_b64_tr_b16 v[168:169], v9 offset:0
    v_mfma_f32_16x16x32_bf16 v[84:87], v[200:203], v[180:183], v[84:87]
    ds_read_b64_tr_b16 v[170:171], v9 offset:7168
    v_mfma_f32_16x16x32_bf16 v[88:91], v[204:207], v[180:183], v[88:91]
    s_add_u32 s95, s95, 1
    v_mfma_f32_16x16x32_bf16 v[92:95], v[208:211], v[180:183], v[92:95]
    v_mfma_f32_16x16x32_bf16 v[96:99], v[212:215], v[180:183], v[96:99]
    v_mfma_f32_16x16x32_bf16 v[100:103], v[188:191], v[184:187], v[100:103]
    v_mfma_f32_16x16x32_bf16 v[104:107], v[192:195], v[184:187], v[104:107]
    v_mfma_f32_16x16x32_bf16 v[108:111], v[196:199], v[184:187], v[108:111]
    v_mfma_f32_16x16x32_bf16 v[112:115], v[200:203], v[184:187], v[112:115]
    v_mfma_f32_16x16x32_bf16 v[116:119], v[204:207], v[184:187], v[116:119]
    v_mfma_f32_16x16x32_bf16 v[120:123], v[208:211], v[184:187], v[120:123]
    v_mfma_f32_16x16x32_bf16 v[124:127], v[212:215], v[184:187], v[124:127]
    s_waitcnt lgkmcnt(0)
    v_mfma_f32_16x16x32_bf16 v[16:19], v[144:147], v[128:131], v[16:19]
    ds_read_b128 v[172:175], v14 offset:0
    v_mfma_f32_16x16x32_bf16 v[20:23], v[148:151], v[128:131], v[20:23]
    ds_read_b64_tr_b16 v[188:189], v7 offset:14336
    v_mfma_f32_16x16x32_bf16 v[24:27], v[152:155], v[128:131], v[24:27]
    ds_read_b64_tr_b16 v[190:191], v7 offset:21504
    v_mfma_f32_16x16x32_bf16 v[28:31], v[156:159], v[128:131], v[28:31]
    ds_read_b64_tr_b16 v[192:193], v8 offset:14368
    v_mfma_f32_16x16x32_bf16 v[32:35], v[160:163], v[128:131], v[32:35]
    ds_read_b64_tr_b16 v[194:195], v8 offset:21536
    v_mfma_f32_16x16x32_bf16 v[36:39], v[164:167], v[128:131], v[36:39]
    ds_read_b128 v[176:179], v14 offset:2048
    v_mfma_f32_16x16x32_bf16 v[40:43], v[168:171], v[128:131], v[40:43]
    ds_read_b64_tr_b16 v[196:197], v7 offset:14400
    v_mfma_f32_16x16x32_bf16 v[44:47], v[144:147], v[132:135], v[44:47]
    ds_read_b64_tr_b16 v[198:199], v7 offset:21568
    v_mfma_f32_16x16x32_bf16 v[48:51], v[148:151], v[132:135], v[48:51]
    ds_read_b64_tr_b16 v[200:201], v8 offset:14432
    v_mfma_f32_16x16x32_bf16 v[52:55], v[152:155], v[132:135], v[52:55]
    ds_read_b64_tr_b16 v[202:203], v8 offset:21600
    v_mfma_f32_16x16x32_bf16 v[56:59], v[156:159], v[132:135], v[56:59]
    ds_read_b128 v[180:183], v14 offset:4096
    v_mfma_f32_16x16x32_bf16 v[60:63], v[160:163], v[132:135], v[60:63]
    ds_read_b64_tr_b16 v[204:205], v7 offset:14464
    v_mfma_f32_16x16x32_bf16 v[64:67], v[164:167], v[132:135], v[64:67]
    ds_read_b64_tr_b16 v[206:207], v7 offset:21632
    v_mfma_f32_16x16x32_bf16 v[68:71], v[168:171], v[132:135], v[68:71]
    ds_read_b64_tr_b16 v[208:209], v8 offset:14496
    v_mfma_f32_16x16x32_bf16 v[72:75], v[144:147], v[136:139], v[72:75]
    ds_read_b64_tr_b16 v[210:211], v8 offset:21664
    v_mfma_f32_16x16x32_bf16 v[76:79], v[148:151], v[136:139], v[76:79]
    ds_read_b128 v[184:187], v14 offset:6144
    v_mfma_f32_16x16x32_bf16 v[80:83], v[152:155], v[136:139], v[80:83]
    ds_read_b64_tr_b16 v[212:213], v9 offset:14336
    v_mfma_f32_16x16x32_bf16 v[84:87], v[156:159], v[136:139], v[84:87]
    ds_read_b64_tr_b16 v[214:215], v9 offset:21504
    v_mfma_f32_16x16x32_bf16 v[88:91], v[160:163], v[136:139], v[88:91]
    s_add_u32 s47, s47, 45056
    v_mfma_f32_16x16x32_bf16 v[92:95], v[164:167], v[136:139], v[92:95]
    s_cmp_eq_u32 s47, 135168
    v_mfma_f32_16x16x32_bf16 v[96:99], v[168:171], v[136:139], v[96:99]
    s_cselect_b32 s47, 0, s47
    v_mfma_f32_16x16x32_bf16 v[100:103], v[144:147], v[140:143], v[100:103]
    v_add_u32 v6, s47, v2
    v_mfma_f32_16x16x32_bf16 v[104:107], v[148:151], v[140:143], v[104:107]
    v_add_u32 v7, s47, v3
    v_mfma_f32_16x16x32_bf16 v[108:111], v[152:155], v[140:143], v[108:111]
    v_add_u32 v8, s47, v4
    v_mfma_f32_16x16x32_bf16 v[112:115], v[156:159], v[140:143], v[112:115]
    v_add_u32 v9, s47, v5
    v_mfma_f32_16x16x32_bf16 v[116:119], v[160:163], v[140:143], v[116:119]
    v_add_u32 v14, s47, v15
    v_mfma_f32_16x16x32_bf16 v[120:123], v[164:167], v[140:143], v[120:123]
    v_mfma_f32_16x16x32_bf16 v[124:127], v[168:171], v[140:143], v[124:127]
    s_waitcnt lgkmcnt(0)
    s_cmp_eq_u32 s95, s94
    s_barrier
    s_cbranch_scc1 L_cs2
L_csr2:
    v_mfma_f32_16x16x32_bf16 v[16:19], v[188:191], v[172:175], v[16:19]
    ds_read_b128 v[128:131], v6 offset:0
    v_mfma_f32_16x16x32_bf16 v[20:23], v[192:195], v[172:175], v[20:23]
    ds_read_b64_tr_b16 v[144:145], v7 offset:0
    v_mfma_f32_16x16x32_bf16 v[24:27], v[196:199], v[172:175], v[24:27]
    ds_read_b64_tr_b16 v[146:147], v7 offset:7168
    v_mfma_f32_16x16x32_bf16 v[28:31], v[200:203], v[172:175], v[28:31]
    ds_read_b64_tr_b16 v[148:149], v8 offset:32
    v_mfma_f32_16x16x32_bf16 v[32:35], v[204:207], v[172:175], v[32:35]
    ds_read_b64_tr_b16 v[150:151], v8 offset:7200
    v_mfma_f32_16x16x32_bf16 v[36:39], v[208:211], v[172:175], v[36:39]
    ds_read_b128 v[132:135], v6 offset:2048
    v_mfma_f32_16x16x32_bf16 v[40:43], v[212:215], v[172:175], v[40:43]
    ds_read_b64_tr_b16 v[152:153], v7 offset:64
    v_mfma_f32_16x16x32_bf16 v[44:47], v[188:191], v[176:179], v[44:47]
    ds_read_b64_tr_b16 v[154:155], v7 offset:7232
    v_mfma_f32_16x16x32_bf16 v[48:51], v[192:195], v[176:179], v[48:51]
    ds_read_b64_tr_b16 v[156:157], v8 offset:96
    v_mfma_f32_16x16x32_bf16 v[52:55], v[196:199], v[176:179], v[52:55]
    ds_read_b64_tr_b16 v[158:159], v8 offset:7264
    v_mfma_f32_16x16x32_bf16 v[56:59], v[200:203], v[176:179], v[56:59]
    ds_read_b128 v[136:139], v6 offset:4096
    v_mfma_f32_16x16x32_bf16 v[60:63], v[204:207], v[176:179], v[60:63]
    ds_read_b64_tr_b16 v[160:161], v7 offset:128
    v_mfma_f32_16x16x32_bf16 v[64:67], v[208:211], v[176:179], v[64:67]
    ds_read_b64_tr_b16 v[162:163], v7 offset:7296
    v_mfma_f32_16x16x32_bf16 v[68:71], v[212:215], v[176:179], v[68:71]
    ds_read_b64_tr_b16 v[164:165], v8 offset:160
    v_mfma_f32_16x16x32_bf16 v[72:75], v[188:191], v[180:183], v[72:75]
    ds_read_b64_tr_b16 v[166:167], v8 offset:7328
    v_mfma_f32_16x16x32_bf16 v[76:79], v[192:195], v[180:183], v[76:79]
    ds_read_b128 v[140:143], v6 offset:6144
    v_mfma_f32_16x16x32_bf16 v[80:83], v[196:199], v[180:183], v[80:83]
    ds_read_b64_tr_b16 v[168:169], v9 offset:0
    v_mfma_f32_16x16x32_bf16 v[84:87], v[200:203], v[180:183], v[84:87]
    ds_read_b64_tr_b16 v[170:171], v9 offset:7168
    v_mfma_f32_16x16x32_bf16 v[88:91], v[204:207], v[180:183], v[88:91]
    s_add_u32 s95, s95, 1
    v_mfma_f32_16x16x32_bf16 v[92:95], v[208:211], v[180:183], v[92:95]
    s_add_u32 s86, s86, 1
    v_mfma_f32_16x16x32_bf16 v[96:99], v[212:215], v[180:183], v[96:99]
    s_cmp_lt_u32 s86, 5
    v_mfma_f32_16x16x32_bf16 v[100:103], v[188:191], v[184:187], v[100:103]
    v_mfma_f32_16x16x32_bf16 v[104:107], v[192:195], v[184:187], v[104:107]
    v_mfma_f32_16x16x32_bf16 v[108:111], v[196:199], v[184:187], v[108:111]
    v_mfma_f32_16x16x32_bf16 v[112:115], v[200:203], v[184:187], v[112:115]
    v_mfma_f32_16x16x32_bf16 v[116:119], v[204:207], v[184:187], v[116:119]
    v_mfma_f32_16x16x32_bf16 v[120:123], v[208:211], v[184:187], v[120:123]
    v_mfma_f32_16x16x32_bf16 v[124:127], v[212:215], v[184:187], v[124:127]
    s_cbranch_scc1 L_c_g1loop
    s_waitcnt lgkmcnt(0)
    v_mfma_f32_16x16x32_bf16 v[16:19], v[144:147], v[128:131], v[16:19]
    ds_read_b128 v[172:175], v14 offset:0
    v_mfma_f32_16x16x32_bf16 v[20:23], v[148:151], v[128:131], v[20:23]
    ds_read_b64_tr_b16 v[188:189], v7 offset:14336
    v_mfma_f32_16x16x32_bf16 v[24:27], v[152:155], v[128:131], v[24:27]
    ds_read_b64_tr_b16 v[190:191], v7 offset:21504
    v_mfma_f32_16x16x32_bf16 v[28:31], v[156:159], v[128:131], v[28:31]
    ds_read_b64_tr_b16 v[192:193], v8 offset:14368
    v_mfma_f32_16x16x32_bf16 v[32:35], v[160:163], v[128:131], v[32:35]
    ds_read_b64_tr_b16 v[194:195], v8 offset:21536
    v_mfma_f32_16x16x32_bf16 v[36:39], v[164:167], v[128:131], v[36:39]
    ds_read_b128 v[176:179], v14 offset:2048
    v_mfma_f32_16x16x32_bf16 v[40:43], v[168:171], v[128:131], v[40:43]
    ds_read_b64_tr_b16 v[196:197], v7 offset:14400
    v_mfma_f32_16x16x32_bf16 v[44:47], v[144:147], v[132:135], v[44:47]
    ds_read_b64_tr_b16 v[198:199], v7 offset:21568
    v_mfma_f32_16x16x32_bf16 v[48:51], v[148:151], v[132:135], v[48:51]
    ds_read_b64_tr_b16 v[200:201], v8 offset:14432
    v_mfma_f32_16x16x32_bf16 v[52:55], v[152:155], v[132:135], v[52:55]
    ds_read_b64_tr_b16 v[202:203], v8 offset:21600
    v_mfma_f32_16x16x32_bf16 v[56:59], v[156:159], v[132:135], v[56:59]
    ds_read_b128 v[180:183], v14 offset:4096
    v_mfma_f32_16x16x32_bf16 v[60:63], v[160:163], v[132:135], v[60:63]
    ds_read_b64_tr_b16 v[204:205], v7 offset:14464
    v_mfma_f32_16x16x32_bf16 v[64:67], v[164:167], v[132:135], v[64:67]
    ds_read_b64_tr_b16 v[206:207], v7 offset:21632
    v_mfma_f32_16x16x32_bf16 v[68:71], v[168:171], v[132:135], v[68:71]
    ds_read_b64_tr_b16 v[208:209], v8 offset:14496
    v_mfma_f32_16x16x32_bf16 v[72:75], v[144:147], v[136:139], v[72:75]
    ds_read_b64_tr_b16 v[210:211], v8 offset:21664
    v_mfma_f32_16x16x32_bf16 v[76:79], v[148:151], v[136:139], v[76:79]
    ds_read_b128 v[184:187], v14 offset:6144
    v_mfma_f32_16x16x32_bf16 v[80:83], v[152:155], v[136:139], v[80:83]
    ds_read_b64_tr_b16 v[212:213], v9 offset:14336
    v_mfma_f32_16x16x32_bf16 v[84:87], v[156:159], v[136:139], v[84:87]
    ds_read_b64_tr_b16 v[214:215], v9 offset:21504
    v_mfma_f32_16x16x32_bf16 v[88:91], v[160:163], v[136:139], v[88:91]
    v_mfma_f32_16x16x32_bf16 v[92:95], v[164:167], v[136:139], v[92:95]
    v_mfma_f32_16x16x32_bf16 v[96:99], v[168:171], v[136:139], v[96:99]
    v_mfma_f32_16x16x32_bf16 v[100:103], v[144:147], v[140:143], v[100:103]
    v_mfma_f32_16x16x32_bf16 v[104:107], v[148:151], v[140:143], v[104:107]
    v_mfma_f32_16x16x32_bf16 v[108:111], v[152:155], v[140:143], v[108:111]
    v_mfma_f32_16x16x32_bf16 v[112:115], v[156:159], v[140:143], v[112:115]
    v_mfma_f32_16x16x32_bf16 v[116:119], v[160:163], v[140:143], v[116:119]
    v_mfma_f32_16x16x32_bf16 v[120:123], v[164:167], v[140:143], v[120:123]
    v_mfma_f32_16x16x32_bf16 v[124:127], v[168:171], v[140:143], v[124:127]
    s_waitcnt lgkmcnt(0)
    v_mfma_f32_16x16x32_bf16 v[16:19], v[188:191], v[172:175], v[16:19]
    v_and_b32 v9, 7, v1
    v_lshlrev_b32 v9, 19, v9
    v_bfe_u32 v8, v1, 3, 1
    v_mfma_f32_16x16x32_bf16 v[20:23], v[192:195], v[172:175], v[20:23]
    v_lshl_add_u32 v9, v8, 14, v9
    v_bfe_u32 v8, v1, 4, 1
    v_lshl_add_u32 v9, v8, 5, v9
    v_mfma_f32_16x16x32_bf16 v[24:27], v[196:199], v[172:175], v[24:27]
    v_bfe_u32 v8, v1, 5, 1
    v_lshl_add_u32 v9, v8, 4, v9
    s_lshl_b32 s48, s45, 4
    v_mfma_f32_16x16x32_bf16 v[28:31], v[200:203], v[172:175], v[28:31]
    s_lshl_b32 s49, s100, 3
    s_add_u32 s48, s48, s49
    s_lshl_b32 s49, s41, 2
    v_mfma_f32_16x16x32_bf16 v[32:35], v[204:207], v[172:175], v[32:35]
    s_add_u32 s48, s48, s49
    s_lshl_b32 s48, s48, 3
    s_add_u32 s48, s48, s44
    v_mfma_f32_16x16x32_bf16 v[36:39], v[208:211], v[172:175], v[36:39]
    s_lshl_b32 s48, s48, 11
    s_lshl_b32 s49, s42, 8
    s_add_u32 s48, s48, s49
    v_mfma_f32_16x16x32_bf16 v[40:43], v[212:215], v[172:175], v[40:43]
    s_lshl_b32 s49, s101, 7
    s_add_u32 s91, s48, s49
    s_add_u32 s92, s91, 32768
    v_mfma_f32_16x16x32_bf16 v[44:47], v[188:191], v[176:179], v[44:47]
    buffer_load_dwordx4 v[224:227], v9, s[4:7], s91 offen offset:0
    buffer_load_dwordx4 v[228:231], v9, s[4:7], s91 offen offset:64
    buffer_load_dwordx4 v[232:235], v9, s[4:7], s92 offen offset:0
    v_mfma_f32_16x16x32_bf16 v[48:51], v[192:195], v[176:179], v[48:51]
    buffer_load_dwordx4 v[236:239], v9, s[4:7], s92 offen offset:64
    v_lshrrev_b32 v10, 4, v1
    v_lshlrev_b32 v10, 4, v10
    v_mfma_f32_16x16x32_bf16 v[52:55], v[196:199], v[176:179], v[52:55]
    s_mul_i32 s48, s101, 384
    s_add_u32 s48, s48, 136192
    v_add_u32 v11, s48, v10
    v_mfma_f32_16x16x32_bf16 v[56:59], v[200:203], v[176:179], v[56:59]
    s_lshl_b32 s48, s101, 6
    s_add_u32 s48, s48, 136960
    v_add_u32 v12, s48, v10
    v_mfma_f32_16x16x32_bf16 v[60:63], v[204:207], v[176:179], v[60:63]
    v_and_b32 v10, 15, v1
    v_lshlrev_b32 v10, 3, v10
    s_lshl_b32 s48, s100, 9
    v_mfma_f32_16x16x32_bf16 v[64:67], v[208:211], v[176:179], v[64:67]
    s_add_u32 s48, s48, 135168
    v_add_u32 v10, s48, v10
    s_lshl_b32 s48, s100, 12
    v_mfma_f32_16x16x32_bf16 v[68:71], v[212:215], v[176:179], v[68:71]
    s_add_u32 s48, s48, 0
    v_add_u32 v2, s48, v240
    s_add_u32 s48, s48, 98304
    v_mfma_f32_16x16x32_bf16 v[72:75], v[188:191], v[180:183], v[72:75]
    s_lshl_b32 s54, s101, 3
    s_add_u32 s54, s54, s48
    v_add_u32 v3, s54, v240
    v_mfma_f32_16x16x32_bf16 v[76:79], v[192:195], v[180:183], v[76:79]
    s_lshl_b32 s54, s101, 11
    s_add_u32 s48, s48, s54
    v_add_u32 v4, s48, v240
    v_mfma_f32_16x16x32_bf16 v[80:83], v[196:199], v[180:183], v[80:83]
    s_mul_i32 s48, s43, 7
    s_mul_i32 s49, s101, 3
    s_add_u32 s49, s49, s48
    v_mfma_f32_16x16x32_bf16 v[84:87], v[200:203], v[180:183], v[84:87]
    s_lshl_b32 s49, s49, 13
    s_lshl_b32 s53, s40, 20
    s_add_u32 s49, s49, s53
    v_mfma_f32_16x16x32_bf16 v[88:91], v[204:207], v[180:183], v[88:91]
    s_add_u32 s50, s49, 8192
    s_add_u32 s51, s49, 16384
    s_add_u32 s52, s48, 6
    v_mfma_f32_16x16x32_bf16 v[92:95], v[208:211], v[180:183], v[92:95]
    s_lshl_b32 s52, s52, 13
    s_add_u32 s52, s52, s53
    s_add_u32 s52, s52, s54
    v_mfma_f32_16x16x32_bf16 v[96:99], v[212:215], v[180:183], v[96:99]
    v_mov_b32 v13, 141376
    s_mul_i32 s48, s101, 40960
    v_add_u32 v6, s48, v2
    v_mfma_f32_16x16x32_bf16 v[100:103], v[188:191], v[184:187], v[100:103]
    s_lshl_b32 s48, s101, 14
    s_add_u32 s48, s48, 8192
    v_add_u32 v7, s48, v6
    v_mfma_f32_16x16x32_bf16 v[104:107], v[192:195], v[184:187], v[104:107]
    v_mfma_f32_16x16x32_bf16 v[108:111], v[196:199], v[184:187], v[108:111]
    v_mfma_f32_16x16x32_bf16 v[112:115], v[200:203], v[184:187], v[112:115]
    v_mfma_f32_16x16x32_bf16 v[116:119], v[204:207], v[184:187], v[116:119]
    v_mfma_f32_16x16x32_bf16 v[120:123], v[208:211], v[184:187], v[120:123]
    v_mfma_f32_16x16x32_bf16 v[124:127], v[212:215], v[184:187], v[124:127]
    s_barrier
    s_setprio 1
    s_branch L_epi
L_epi_ret_c:
    v_readfirstlane_b32 s96, v241
    s_lshl_b32 s48, s100, 12
    s_lshl_b32 s49, s41, 11
    s_add_u32 s50, s48, s49
    v_add_u32 v2, s50, v240
    s_xor_b32 s49, s49, 2048
    s_add_u32 s50, s48, s49
    v_add_u32 v3, s50, v240
    v_lshrrev_b32 v11, 2, v1
    v_and_b32 v12, 7, v11
    v_lshlrev_b32 v11, 8, v11
    v_and_b32 v13, 3, v1
    v_lshl_add_u32 v11, v13, 3, v11
    v_add_u32 v11, 16384, v11
    s_lshl_b32 s48, s101, 2
    v_xor_b32 v12, s48, v12
    v_xor_b32 v13, 0, v12
    v_lshl_add_u32 v4, v13, 5, v11
    v_xor_b32 v13, 1, v12
    v_lshl_add_u32 v5, v13, 5, v11
    v_xor_b32 v13, 2, v12
    v_lshl_add_u32 v6, v13, 5, v11
    v_xor_b32 v13, 3, v12
    v_lshl_add_u32 v7, v13, 5, v11
    s_mov_b32 s47, 0
    v_mov_b32 v14, v2
    v_mov_b32 v15, v3
    v_mov_b32 v16, v4
    v_mov_b32 v17, v5
    v_mov_b32 v18, v6
    v_mov_b32 v19, v7
    v_mov_b32 v20, 0
    s_lshl_b32 s48, s46, 2
    s_lshl_b32 s80, s2, 7
    s_add_u32 s80, s80, s48
    s_add_u32 s80, s80, 688128
    s_xor_b32 s81, s80, 512
    s_lshl_b32 s93, s2, 2
    s_add_u32 s93, s93, s46
    s_lshl_b32 s93, s93, 12
    s_add_u32 s93, s93, 1048576
    s_xor_b32 s94, s93, 65536
    s_setprio 2
    s_waitcnt lgkmcnt(0)
    s_barrier
    ds_read_b128 v[128:131], v14 offset:0
    ds_read_b64_tr_b16 v[144:145], v16 offset:0
    ds_read_b64_tr_b16 v[146:147], v16 offset:4096
    ds_read_b128 v[132:135], v14 offset:1024
    ds_read_b64_tr_b16 v[148:149], v17 offset:0
    ds_read_b64_tr_b16 v[150:151], v17 offset:4096
    ds_read_b128 v[136:139], v15 offset:0
    ds_read_b64_tr_b16 v[152:153], v18 offset:0
    ds_read_b64_tr_b16 v[154:155], v18 offset:4096
    ds_read_b128 v[140:143], v15 offset:1024
    ds_read_b64_tr_b16 v[156:157], v19 offset:0
    ds_read_b64_tr_b16 v[158:159], v19 offset:4096
    s_waitcnt lgkmcnt(0)
    v_mfma_f32_16x16x32_bf16 v[32:35], v[144:147], v[128:131], 0
    ds_read_b128 v[160:163], v14 offset:8192
    ds_read_b64_tr_b16 v[176:177], v16 offset:8192
    v_mfma_f32_16x16x32_bf16 v[36:39], v[148:151], v[128:131], 0
    ds_read_b64_tr_b16 v[178:179], v16 offset:12288
    ds_read_b128 v[164:167], v14 offset:9216
    v_mfma_f32_16x16x32_bf16 v[40:43], v[152:155], v[128:131], 0
    ds_read_b64_tr_b16 v[180:181], v17 offset:8192
    v_mfma_f32_16x16x32_bf16 v[44:47], v[156:159], v[128:131], 0
    ds_read_b64_tr_b16 v[182:183], v17 offset:12288
    v_mfma_f32_16x16x32_bf16 v[48:51], v[144:147], v[132:135], 0
    ds_read_b128 v[168:171], v15 offset:8192
    v_mfma_f32_16x16x32_bf16 v[52:55], v[148:151], v[132:135], 0
    ds_read_b64_tr_b16 v[184:185], v18 offset:8192
    v_mfma_f32_16x16x32_bf16 v[56:59], v[152:155], v[132:135], 0
    ds_read_b64_tr_b16 v[186:187], v18 offset:12288
    v_mfma_f32_16x16x32_bf16 v[60:63], v[156:159], v[132:135], 0
    ds_read_b128 v[172:175], v15 offset:9216
    v_mfma_f32_16x16x32_bf16 v[64:67], v[144:147], v[136:139], 0
    ds_read_b64_tr_b16 v[188:189], v19 offset:8192
    v_mfma_f32_16x16x32_bf16 v[68:71], v[148:151], v[136:139], 0
    ds_read_b64_tr_b16 v[190:191], v19 offset:12288
    v_mfma_f32_16x16x32_bf16 v[72:75], v[152:155], v[136:139], 0
    s_add_u32 s47, s47, 32768
    s_and_b32 s47, s47, 131071
    v_mfma_f32_16x16x32_bf16 v[76:79], v[156:159], v[136:139], 0
    v_add_u32 v14, s47, v2
    v_add_u32 v15, s47, v3
    v_mfma_f32_16x16x32_bf16 v[80:83], v[144:147], v[140:143], 0
    v_add_u32 v16, s47, v4
    v_add_u32 v17, s47, v5
    v_mfma_f32_16x16x32_bf16 v[84:87], v[148:151], v[140:143], 0
    v_add_u32 v18, s47, v6
    v_add_u32 v19, s47, v7
    v_mfma_f32_16x16x32_bf16 v[88:91], v[152:155], v[140:143], 0
    v_mfma_f32_16x16x32_bf16 v[92:95], v[156:159], v[140:143], 0
    s_waitcnt vmcnt(0)
    s_mov_b64 exec, 1
    buffer_store_dword v241, v20, s[32:35], s79 offen sc1
    s_mov_b64 exec, -1
    s_waitcnt lgkmcnt(0)
    s_barrier
    v_mfma_f32_16x16x32_bf16 v[32:35], v[176:179], v[160:163], v[32:35]
    ds_read_b128 v[128:131], v14 offset:0
    ds_read_b64_tr_b16 v[144:145], v16 offset:0
    v_mfma_f32_16x16x32_bf16 v[36:39], v[180:183], v[160:163], v[36:39]
    ds_read_b64_tr_b16 v[146:147], v16 offset:4096
    ds_read_b128 v[132:135], v14 offset:1024
    v_mfma_f32_16x16x32_bf16 v[40:43], v[184:187], v[160:163], v[40:43]
    ds_read_b64_tr_b16 v[148:149], v17 offset:0
    v_mfma_f32_16x16x32_bf16 v[44:47], v[188:191], v[160:163], v[44:47]
    ds_read_b64_tr_b16 v[150:151], v17 offset:4096
    v_mfma_f32_16x16x32_bf16 v[48:51], v[176:179], v[164:167], v[48:51]
    ds_read_b128 v[136:139], v15 offset:0
    v_mfma_f32_16x16x32_bf16 v[52:55], v[180:183], v[164:167], v[52:55]
    ds_read_b64_tr_b16 v[152:153], v18 offset:0
    v_mfma_f32_16x16x32_bf16 v[56:59], v[184:187], v[164:167], v[56:59]
    ds_read_b64_tr_b16 v[154:155], v18 offset:4096
    v_mfma_f32_16x16x32_bf16 v[60:63], v[188:191], v[164:167], v[60:63]
    ds_read_b128 v[140:143], v15 offset:1024
    v_mfma_f32_16x16x32_bf16 v[64:67], v[176:179], v[168:171], v[64:67]
    ds_read_b64_tr_b16 v[156:157], v19 offset:0
    v_mfma_f32_16x16x32_bf16 v[68:71], v[180:183], v[168:171], v[68:71]
    ds_read_b64_tr_b16 v[158:159], v19 offset:4096
    v_mfma_f32_16x16x32_bf16 v[72:75], v[184:187], v[168:171], v[72:75]
    v_mfma_f32_16x16x32_bf16 v[76:79], v[188:191], v[168:171], v[76:79]
    v_mfma_f32_16x16x32_bf16 v[80:83], v[176:179], v[172:175], v[80:83]
    v_mfma_f32_16x16x32_bf16 v[84:87], v[180:183], v[172:175], v[84:87]
    v_mfma_f32_16x16x32_bf16 v[88:91], v[184:187], v[172:175], v[88:91]
    v_mfma_f32_16x16x32_bf16 v[92:95], v[188:191], v[172:175], v[92:95]
    s_waitcnt lgkmcnt(0)
    v_mfma_f32_16x16x32_bf16 v[32:35], v[144:147], v[128:131], v[32:35]
    ds_read_b128 v[160:163], v14 offset:8192
    ds_read_b64_tr_b16 v[176:177], v16 offset:8192
    v_mfma_f32_16x16x32_bf16 v[36:39], v[148:151], v[128:131], v[36:39]
    ds_read_b64_tr_b16 v[178:179], v16 offset:12288
    ds_read_b128 v[164:167], v14 offset:9216
    v_mfma_f32_16x16x32_bf16 v[40:43], v[152:155], v[128:131], v[40:43]
    ds_read_b64_tr_b16 v[180:181], v17 offset:8192
    v_mfma_f32_16x16x32_bf16 v[44:47], v[156:159], v[128:131], v[44:47]
    ds_read_b64_tr_b16 v[182:183], v17 offset:12288
    v_mfma_f32_16x16x32_bf16 v[48:51], v[144:147], v[132:135], v[48:51]
    ds_read_b128 v[168:171], v15 offset:8192
    v_mfma_f32_16x16x32_bf16 v[52:55], v[148:151], v[132:135], v[52:55]
    ds_read_b64_tr_b16 v[184:185], v18 offset:8192
    v_mfma_f32_16x16x32_bf16 v[56:59], v[152:155], v[132:135], v[56:59]
    ds_read_b64_tr_b16 v[186:187], v18 offset:12288
    v_mfma_f32_16x16x32_bf16 v[60:63], v[156:159], v[132:135], v[60:63]
    ds_read_b128 v[172:175], v15 offset:9216
    v_mfma_f32_16x16x32_bf16 v[64:67], v[144:147], v[136:139], v[64:67]
    ds_read_b64_tr_b16 v[188:189], v19 offset:8192
    v_mfma_f32_16x16x32_bf16 v[68:71], v[148:151], v[136:139], v[68:71]
    ds_read_b64_tr_b16 v[190:191], v19 offset:12288
    v_mfma_f32_16x16x32_bf16 v[72:75], v[152:155], v[136:139], v[72:75]
    s_add_u32 s47, s47, 32768
    s_and_b32 s47, s47, 131071
    v_mfma_f32_16x16x32_bf16 v[76:79], v[156:159], v[136:139], v[76:79]
    v_add_u32 v14, s47, v2
    v_add_u32 v15, s47, v3
    v_mfma_f32_16x16x32_bf16 v[80:83], v[144:147], v[140:143], v[80:83]
    v_add_u32 v16, s47, v4
    v_add_u32 v17, s47, v5
    v_mfma_f32_16x16x32_bf16 v[84:87], v[148:151], v[140:143], v[84:87]
    v_add_u32 v18, s47, v6
    v_add_u32 v19, s47, v7
    v_mfma_f32_16x16x32_bf16 v[88:91], v[152:155], v[140:143], v[88:91]
    v_mfma_f32_16x16x32_bf16 v[92:95], v[156:159], v[140:143], v[92:95]
    s_waitcnt lgkmcnt(0)
    s_barrier
    v_mfma_f32_16x16x32_bf16 v[32:35], v[176:179], v[160:163], v[32:35]
    ds_read_b128 v[128:131], v14 offset:0
    ds_read_b64_tr_b16 v[144:145], v16 offset:0
    v_mfma_f32_16x16x32_bf16 v[36:39], v[180:183], v[160:163], v[36:39]
    ds_read_b64_tr_b16 v[146:147], v16 offset:4096
    ds_read_b128 v[132:135], v14 offset:1024
    v_mfma_f32_16x16x32_bf16 v[40:43], v[184:187], v[160:163], v[40:43]
    ds_read_b64_tr_b16 v[148:149], v17 offset:0
    ds_read_b64_tr_b16 v[150:151], v17 offset:4096
    v_mfma_f32_16x16x32_bf16 v[44:47], v[188:191], v[160:163], v[44:47]
    ds_read_b128 v[136:139], v15 offset:0
    ds_read_b64_tr_b16 v[152:153], v18 offset:0
    v_mfma_f32_16x16x32_bf16 v[48:51], v[176:179], v[164:167], v[48:51]
    ds_read_b64_tr_b16 v[154:155], v18 offset:4096
    ds_read_b128 v[140:143], v15 offset:1024
    v_mfma_f32_16x16x32_bf16 v[52:55], v[180:183], v[164:167], v[52:55]
    ds_read_b64_tr_b16 v[156:157], v19 offset:0
    ds_read_b64_tr_b16 v[158:159], v19 offset:4096
    v_mfma_f32_16x16x32_bf16 v[56:59], v[184:187], v[164:167], v[56:59]
    v_permlane16_swap_b32 v224, v226
    v_permlane16_swap_b32 v225, v227
    v_mfma_f32_16x16x32_bf16 v[60:63], v[188:191], v[164:167], v[60:63]
    v_permlane16_swap_b32 v228, v230
    v_permlane16_swap_b32 v229, v231
    v_mfma_f32_16x16x32_bf16 v[64:67], v[176:179], v[168:171], v[64:67]
    v_permlane16_swap_b32 v232, v234
    v_permlane16_swap_b32 v233, v235
    v_mfma_f32_16x16x32_bf16 v[68:71], v[180:183], v[168:171], v[68:71]
    v_permlane16_swap_b32 v236, v238
    v_permlane16_swap_b32 v237, v239
    v_mfma_f32_16x16x32_bf16 v[72:75], v[184:187], v[168:171], v[72:75]
    v_lshlrev_b32 v192, 16, v224
    v_and_b32 v193, 0xffff0000, v224
    v_mfma_f32_16x16x32_bf16 v[76:79], v[188:191], v[168:171], v[76:79]
    v_lshlrev_b32 v194, 16, v225
    v_and_b32 v195, 0xffff0000, v225
    v_mfma_f32_16x16x32_bf16 v[80:83], v[176:179], v[172:175], v[80:83]
    v_lshlrev_b32 v196, 16, v226
    v_and_b32 v197, 0xffff0000, v226
    v_mfma_f32_16x16x32_bf16 v[84:87], v[180:183], v[172:175], v[84:87]
    v_lshlrev_b32 v198, 16, v227
    v_and_b32 v199, 0xffff0000, v227
    v_mfma_f32_16x16x32_bf16 v[88:91], v[184:187], v[172:175], v[88:91]
    v_lshlrev_b32 v200, 16, v228
    v_and_b32 v201, 0xffff0000, v228
    v_mfma_f32_16x16x32_bf16 v[92:95], v[188:191], v[172:175], v[92:95]
    v_lshlrev_b32 v202, 16, v229
    v_and_b32 v203, 0xffff0000, v229
    s_waitcnt lgkmcnt(0)
    v_mfma_f32_16x16x32_bf16 v[32:35], v[144:147], v[128:131], v[32:35]
    ds_read_b128 v[160:163], v14 offset:8192
    ds_read_b64_tr_b16 v[176:177], v16 offset:8192
    v_mfma_f32_16x16x32_bf16 v[36:39], v[148:151], v[128:131], v[36:39]
    ds_read_b64_tr_b16 v[178:179], v16 offset:12288
    ds_read_b128 v[164:167], v14 offset:9216
    v_mfma_f32_16x16x32_bf16 v[40:43], v[152:155], v[128:131], v[40:43]
    ds_read_b64_tr_b16 v[180:181], v17 offset:8192
    v_mfma_f32_16x16x32_bf16 v[44:47], v[156:159], v[128:131], v[44:47]
    ds_read_b64_tr_b16 v[182:183], v17 offset:12288
    v_mfma_f32_16x16x32_bf16 v[48:51], v[144:147], v[132:135], v[48:51]
    ds_read_b128 v[168:171], v15 offset:8192
    v_mfma_f32_16x16x32_bf16 v[52:55], v[148:151], v[132:135], v[52:55]
    ds_read_b64_tr_b16 v[184:185], v18 offset:8192
    v_mfma_f32_16x16x32_bf16 v[56:59], v[152:155], v[132:135], v[56:59]
    ds_read_b64_tr_b16 v[186:187], v18 offset:12288
    v_mfma_f32_16x16x32_bf16 v[60:63], v[156:159], v[132:135], v[60:63]
    ds_read_b128 v[172:175], v15 offset:9216
    v_mfma_f32_16x16x32_bf16 v[64:67], v[144:147], v[136:139], v[64:67]
    ds_read_b64_tr_b16 v[188:189], v19 offset:8192
    v_mfma_f32_16x16x32_bf16 v[68:71], v[148:151], v[136:139], v[68:71]
    ds_read_b64_tr_b16 v[190:191], v19 offset:12288
    v_mfma_f32_16x16x32_bf16 v[72:75], v[152:155], v[136:139], v[72:75]
    s_add_u32 s47, s47, 32768
    s_and_b32 s47, s47, 131071
    v_mfma_f32_16x16x32_bf16 v[76:79], v[156:159], v[136:139], v[76:79]
    v_add_u32 v14, s47, v2
    v_add_u32 v15, s47, v3
    v_mfma_f32_16x16x32_bf16 v[80:83], v[144:147], v[140:143], v[80:83]
    v_add_u32 v16, s47, v4
    v_add_u32 v17, s47, v5
    v_mfma_f32_16x16x32_bf16 v[84:87], v[148:151], v[140:143], v[84:87]
    v_add_u32 v18, s47, v6
    v_add_u32 v19, s47, v7
    v_mfma_f32_16x16x32_bf16 v[88:91], v[152:155], v[140:143], v[88:91]
    v_mfma_f32_16x16x32_bf16 v[92:95], v[156:159], v[140:143], v[92:95]
    s_waitcnt lgkmcnt(0)
    s_barrier
    v_mfma_f32_16x16x32_bf16 v[32:35], v[176:179], v[160:163], v[32:35]
    ds_read_b128 v[128:131], v14 offset:0
    ds_read_b64_tr_b16 v[144:145], v16 offset:0
    v_mfma_f32_16x16x32_bf16 v[36:39], v[180:183], v[160:163], v[36:39]
    ds_read_b64_tr_b16 v[146:147], v16 offset:4096
    ds_read_b128 v[132:135], v14 offset:1024
    v_mfma_f32_16x16x32_bf16 v[40:43], v[184:187], v[160:163], v[40:43]
    ds_read_b64_tr_b16 v[148:149], v17 offset:0
    ds_read_b64_tr_b16 v[150:151], v17 offset:4096
    v_mfma_f32_16x16x32_bf16 v[44:47], v[188:191], v[160:163], v[44:47]
    ds_read_b128 v[136:139], v15 offset:0
    ds_read_b64_tr_b16 v[152:153], v18 offset:0
    v_mfma_f32_16x16x32_bf16 v[48:51], v[176:179], v[164:167], v[48:51]
    ds_read_b64_tr_b16 v[154:155], v18 offset:4096
    ds_read_b128 v[140:143], v15 offset:1024
    v_mfma_f32_16x16x32_bf16 v[52:55], v[180:183], v[164:167], v[52:55]
    ds_read_b64_tr_b16 v[156:157], v19 offset:0
    ds_read_b64_tr_b16 v[158:159], v19 offset:4096
    v_mfma_f32_16x16x32_bf16 v[56:59], v[184:187], v[164:167], v[56:59]
    v_lshlrev_b32 v204, 16, v230
    v_and_b32 v205, 0xffff0000, v230
    v_mfma_f32_16x16x32_bf16 v[60:63], v[188:191], v[164:167], v[60:63]
    v_lshlrev_b32 v206, 16, v231
    v_and_b32 v207, 0xffff0000, v231
    v_mfma_f32_16x16x32_bf16 v[64:67], v[176:179], v[168:171], v[64:67]
    v_lshlrev_b32 v208, 16, v232
    v_and_b32 v209, 0xffff0000, v232
    v_mfma_f32_16x16x32_bf16 v[68:71], v[180:183], v[168:171], v[68:71]
    v_lshlrev_b32 v210, 16, v233
    v_and_b32 v211, 0xffff0000, v233
    v_mfma_f32_16x16x32_bf16 v[72:75], v[184:187], v[168:171], v[72:75]
    v_lshlrev_b32 v212, 16, v234
    v_and_b32 v213, 0xffff0000, v234
    v_mfma_f32_16x16x32_bf16 v[76:79], v[188:191], v[168:171], v[76:79]
    v_lshlrev_b32 v214, 16, v235
    v_and_b32 v215, 0xffff0000, v235
    v_mfma_f32_16x16x32_bf16 v[80:83], v[176:179], v[172:175], v[80:83]
    v_lshlrev_b32 v216, 16, v236
    v_and_b32 v217, 0xffff0000, v236
    v_mfma_f32_16x16x32_bf16 v[84:87], v[180:183], v[172:175], v[84:87]
    v_lshlrev_b32 v218, 16, v237
    v_and_b32 v219, 0xffff0000, v237
    v_mfma_f32_16x16x32_bf16 v[88:91], v[184:187], v[172:175], v[88:91]
    v_lshlrev_b32 v220, 16, v238
    v_and_b32 v221, 0xffff0000, v238
    v_mfma_f32_16x16x32_bf16 v[92:95], v[188:191], v[172:175], v[92:95]
    v_lshlrev_b32 v222, 16, v239
    v_and_b32 v223, 0xffff0000, v239
    s_mov_b32 s86, 1
L_c_g2loop:
    s_waitcnt lgkmcnt(0)
    v_mfma_f32_16x16x32_bf16 v[32:35], v[144:147], v[128:131], v[32:35]
    ds_read_b128 v[160:163], v14 offset:8192
    ds_read_b64_tr_b16 v[176:177], v16 offset:8192
    v_mfma_f32_16x16x32_bf16 v[36:39], v[148:151], v[128:131], v[36:39]
    ds_read_b64_tr_b16 v[178:179], v16 offset:12288
    ds_read_b128 v[164:167], v14 offset:9216
    v_mfma_f32_16x16x32_bf16 v[40:43], v[152:155], v[128:131], v[40:43]
    ds_read_b64_tr_b16 v[180:181], v17 offset:8192
    v_mfma_f32_16x16x32_bf16 v[44:47], v[156:159], v[128:131], v[44:47]
    ds_read_b64_tr_b16 v[182:183], v17 offset:12288
    v_mfma_f32_16x16x32_bf16 v[48:51], v[144:147], v[132:135], v[48:51]
    ds_read_b128 v[168:171], v15 offset:8192
    v_mfma_f32_16x16x32_bf16 v[52:55], v[148:151], v[132:135], v[52:55]
    ds_read_b64_tr_b16 v[184:185], v18 offset:8192
    v_mfma_f32_16x16x32_bf16 v[56:59], v[152:155], v[132:135], v[56:59]
    ds_read_b64_tr_b16 v[186:187], v18 offset:12288
    v_mfma_f32_16x16x32_bf16 v[60:63], v[156:159], v[132:135], v[60:63]
    ds_read_b128 v[172:175], v15 offset:9216
    v_mfma_f32_16x16x32_bf16 v[64:67], v[144:147], v[136:139], v[64:67]
    ds_read_b64_tr_b16 v[188:189], v19 offset:8192
    v_mfma_f32_16x16x32_bf16 v[68:71], v[148:151], v[136:139], v[68:71]
    ds_read_b64_tr_b16 v[190:191], v19 offset:12288
    v_mfma_f32_16x16x32_bf16 v[72:75], v[152:155], v[136:139], v[72:75]
    s_add_u32 s47, s47, 32768
    s_and_b32 s47, s47, 131071
    v_mfma_f32_16x16x32_bf16 v[76:79], v[156:159], v[136:139], v[76:79]
    v_add_u32 v14, s47, v2
    v_add_u32 v15, s47, v3
    v_mfma_f32_16x16x32_bf16 v[80:83], v[144:147], v[140:143], v[80:83]
    v_add_u32 v16, s47, v4
    v_add_u32 v17, s47, v5
    v_mfma_f32_16x16x32_bf16 v[84:87], v[148:151], v[140:143], v[84:87]
    v_add_u32 v18, s47, v6
    v_add_u32 v19, s47, v7
    v_mfma_f32_16x16x32_bf16 v[88:91], v[152:155], v[140:143], v[88:91]
    v_mfma_f32_16x16x32_bf16 v[92:95], v[156:159], v[140:143], v[92:95]
    s_waitcnt lgkmcnt(0)
    s_barrier
    v_mfma_f32_16x16x32_bf16 v[32:35], v[176:179], v[160:163], v[32:35]
    ds_read_b128 v[128:131], v14 offset:0
    ds_read_b64_tr_b16 v[144:145], v16 offset:0
    v_mfma_f32_16x16x32_bf16 v[36:39], v[180:183], v[160:163], v[36:39]
    ds_read_b64_tr_b16 v[146:147], v16 offset:4096
    ds_read_b128 v[132:135], v14 offset:1024
    v_mfma_f32_16x16x32_bf16 v[40:43], v[184:187], v[160:163], v[40:43]
    ds_read_b64_tr_b16 v[148:149], v17 offset:0
    v_mfma_f32_16x16x32_bf16 v[44:47], v[188:191], v[160:163], v[44:47]
    ds_read_b64_tr_b16 v[150:151], v17 offset:4096
    v_mfma_f32_16x16x32_bf16 v[48:51], v[176:179], v[164:167], v[48:51]
    ds_read_b128 v[136:139], v15 offset:0
    v_mfma_f32_16x16x32_bf16 v[52:55], v[180:183], v[164:167], v[52:55]
    ds_read_b64_tr_b16 v[152:153], v18 offset:0
    v_mfma_f32_16x16x32_bf16 v[56:59], v[184:187], v[164:167], v[56:59]
    ds_read_b64_tr_b16 v[154:155], v18 offset:4096
    v_mfma_f32_16x16x32_bf16 v[60:63], v[188:191], v[164:167], v[60:63]
    ds_read_b128 v[140:143], v15 offset:1024
    v_mfma_f32_16x16x32_bf16 v[64:67], v[176:179], v[168:171], v[64:67]
    ds_read_b64_tr_b16 v[156:157], v19 offset:0
    v_mfma_f32_16x16x32_bf16 v[68:71], v[180:183], v[168:171], v[68:71]
    ds_read_b64_tr_b16 v[158:159], v19 offset:4096
    v_mfma_f32_16x16x32_bf16 v[72:75], v[184:187], v[168:171], v[72:75]
    v_mfma_f32_16x16x32_bf16 v[76:79], v[188:191], v[168:171], v[76:79]
    v_mfma_f32_16x16x32_bf16 v[80:83], v[176:179], v[172:175], v[80:83]
    v_mfma_f32_16x16x32_bf16 v[84:87], v[180:183], v[172:175], v[84:87]
    v_mfma_f32_16x16x32_bf16 v[88:91], v[184:187], v[172:175], v[88:91]
    v_mfma_f32_16x16x32_bf16 v[92:95], v[188:191], v[172:175], v[92:95]
    s_waitcnt lgkmcnt(0)
    v_mfma_f32_16x16x32_bf16 v[32:35], v[144:147], v[128:131], v[32:35]
    ds_read_b128 v[160:163], v14 offset:8192
    ds_read_b64_tr_b16 v[176:177], v16 offset:8192
    v_mfma_f32_16x16x32_bf16 v[36:39], v[148:151], v[128:131], v[36:39]
    ds_read_b64_tr_b16 v[178:179], v16 offset:12288
    ds_read_b128 v[164:167], v14 offset:9216
    v_mfma_f32_16x16x32_bf16 v[40:43], v[152:155], v[128:131], v[40:43]
    ds_read_b64_tr_b16 v[180:181], v17 offset:8192
    v_mfma_f32_16x16x32_bf16 v[44:47], v[156:159], v[128:131], v[44:47]
    ds_read_b64_tr_b16 v[182:183], v17 offset:12288
    v_mfma_f32_16x16x32_bf16 v[48:51], v[144:147], v[132:135], v[48:51]
    ds_read_b128 v[168:171], v15 offset:8192
    v_mfma_f32_16x16x32_bf16 v[52:55], v[148:151], v[132:135], v[52:55]
    ds_read_b64_tr_b16 v[184:185], v18 offset:8192
    v_mfma_f32_16x16x32_bf16 v[56:59], v[152:155], v[132:135], v[56:59]
    ds_read_b64_tr_b16 v[186:187], v18 offset:12288
    v_mfma_f32_16x16x32_bf16 v[60:63], v[156:159], v[132:135], v[60:63]
    ds_read_b128 v[172:175], v15 offset:9216
    v_mfma_f32_16x16x32_bf16 v[64:67], v[144:147], v[136:139], v[64:67]
    ds_read_b64_tr_b16 v[188:189], v19 offset:8192
    v_mfma_f32_16x16x32_bf16 v[68:71], v[148:151], v[136:139], v[68:71]
    ds_read_b64_tr_b16 v[190:191], v19 offset:12288
    v_mfma_f32_16x16x32_bf16 v[72:75], v[152:155], v[136:139], v[72:75]
    s_add_u32 s47, s47, 32768
    s_and_b32 s47, s47, 131071
    v_mfma_f32_16x16x32_bf16 v[76:79], v[156:159], v[136:139], v[76:79]
    v_add_u32 v14, s47, v2
    v_add_u32 v15, s47, v3
    v_mfma_f32_16x16x32_bf16 v[80:83], v[144:147], v[140:143], v[80:83]
    v_add_u32 v16, s47, v4
    v_add_u32 v17, s47, v5
    v_mfma_f32_16x16x32_bf16 v[84:87], v[148:151], v[140:143], v[84:87]
    v_add_u32 v18, s47, v6
    v_add_u32 v19, s47, v7
    v_mfma_f32_16x16x32_bf16 v[88:91], v[152:155], v[140:143], v[88:91]
    v_mfma_f32_16x16x32_bf16 v[92:95], v[156:159], v[140:143], v[92:95]
    s_waitcnt lgkmcnt(0)
    s_barrier
    v_mfma_f32_16x16x32_bf16 v[32:35], v[176:179], v[160:163], v[32:35]
    ds_read_b128 v[128:131], v14 offset:0
    ds_read_b64_tr_b16 v[144:145], v16 offset:0
    v_mfma_f32_16x16x32_bf16 v[36:39], v[180:183], v[160:163], v[36:39]
    ds_read_b64_tr_b16 v[146:147], v16 offset:4096
    ds_read_b128 v[132:135], v14 offset:1024
    v_mfma_f32_16x16x32_bf16 v[40:43], v[184:187], v[160:163], v[40:43]
    ds_read_b64_tr_b16 v[148:149], v17 offset:0
    v_mfma_f32_16x16x32_bf16 v[44:47], v[188:191], v[160:163], v[44:47]
    ds_read_b64_tr_b16 v[150:151], v17 offset:4096
    v_mfma_f32_16x16x32_bf16 v[48:51], v[176:179], v[164:167], v[48:51]
    ds_read_b128 v[136:139], v15 offset:0
    v_mfma_f32_16x16x32_bf16 v[52:55], v[180:183], v[164:167], v[52:55]
    ds_read_b64_tr_b16 v[152:153], v18 offset:0
    v_mfma_f32_16x16x32_bf16 v[56:59], v[184:187], v[164:167], v[56:59]
    ds_read_b64_tr_b16 v[154:155], v18 offset:4096
    v_mfma_f32_16x16x32_bf16 v[60:63], v[188:191], v[164:167], v[60:63]
    ds_read_b128 v[140:143], v15 offset:1024
    v_mfma_f32_16x16x32_bf16 v[64:67], v[176:179], v[168:171], v[64:67]
    ds_read_b64_tr_b16 v[156:157], v19 offset:0
    v_mfma_f32_16x16x32_bf16 v[68:71], v[180:183], v[168:171], v[68:71]
    ds_read_b64_tr_b16 v[158:159], v19 offset:4096
    v_mfma_f32_16x16x32_bf16 v[72:75], v[184:187], v[168:171], v[72:75]
    v_mfma_f32_16x16x32_bf16 v[76:79], v[188:191], v[168:171], v[76:79]
    v_mfma_f32_16x16x32_bf16 v[80:83], v[176:179], v[172:175], v[80:83]
    v_mfma_f32_16x16x32_bf16 v[84:87], v[180:183], v[172:175], v[84:87]
    v_mfma_f32_16x16x32_bf16 v[88:91], v[184:187], v[172:175], v[88:91]
    v_mfma_f32_16x16x32_bf16 v[92:95], v[188:191], v[172:175], v[92:95]
    s_waitcnt lgkmcnt(0)
    v_mfma_f32_16x16x32_bf16 v[32:35], v[144:147], v[128:131], v[32:35]
    ds_read_b128 v[160:163], v14 offset:8192
    ds_read_b64_tr_b16 v[176:177], v16 offset:8192
    v_mfma_f32_16x16x32_bf16 v[36:39], v[148:151], v[128:131], v[36:39]
    ds_read_b64_tr_b16 v[178:179], v16 offset:12288
    ds_read_b128 v[164:167], v14 offset:9216
    v_mfma_f32_16x16x32_bf16 v[40:43], v[152:155], v[128:131], v[40:43]
    ds_read_b64_tr_b16 v[180:181], v17 offset:8192
    v_mfma_f32_16x16x32_bf16 v[44:47], v[156:159], v[128:131], v[44:47]
    ds_read_b64_tr_b16 v[182:183], v17 offset:12288
    v_mfma_f32_16x16x32_bf16 v[48:51], v[144:147], v[132:135], v[48:51]
    ds_read_b128 v[168:171], v15 offset:8192
    v_mfma_f32_16x16x32_bf16 v[52:55], v[148:151], v[132:135], v[52:55]
    ds_read_b64_tr_b16 v[184:185], v18 offset:8192
    v_mfma_f32_16x16x32_bf16 v[56:59], v[152:155], v[132:135], v[56:59]
    ds_read_b64_tr_b16 v[186:187], v18 offset:12288
    v_mfma_f32_16x16x32_bf16 v[60:63], v[156:159], v[132:135], v[60:63]
    ds_read_b128 v[172:175], v15 offset:9216
    v_mfma_f32_16x16x32_bf16 v[64:67], v[144:147], v[136:139], v[64:67]
    ds_read_b64_tr_b16 v[188:189], v19 offset:8192
    v_mfma_f32_16x16x32_bf16 v[68:71], v[148:151], v[136:139], v[68:71]
    ds_read_b64_tr_b16 v[190:191], v19 offset:12288
    v_mfma_f32_16x16x32_bf16 v[72:75], v[152:155], v[136:139], v[72:75]
    s_add_u32 s47, s47, 32768
    s_and_b32 s47, s47, 131071
    v_mfma_f32_16x16x32_bf16 v[76:79], v[156:159], v[136:139], v[76:79]
    v_add_u32 v14, s47, v2
    v_add_u32 v15, s47, v3
    v_mfma_f32_16x16x32_bf16 v[80:83], v[144:147], v[140:143], v[80:83]
    v_add_u32 v16, s47, v4
    v_add_u32 v17, s47, v5
    v_mfma_f32_16x16x32_bf16 v[84:87], v[148:151], v[140:143], v[84:87]
    v_add_u32 v18, s47, v6
    v_add_u32 v19, s47, v7
    v_mfma_f32_16x16x32_bf16 v[88:91], v[152:155], v[140:143], v[88:91]
    v_mfma_f32_16x16x32_bf16 v[92:95], v[156:159], v[140:143], v[92:95]
    s_waitcnt lgkmcnt(0)
    s_barrier
    v_mfma_f32_16x16x32_bf16 v[32:35], v[176:179], v[160:163], v[32:35]
    ds_read_b128 v[128:131], v14 offset:0
    ds_read_b64_tr_b16 v[144:145], v16 offset:0
    v_mfma_f32_16x16x32_bf16 v[36:39], v[180:183], v[160:163], v[36:39]
    ds_read_b64_tr_b16 v[146:147], v16 offset:4096
    ds_read_b128 v[132:135], v14 offset:1024
    v_mfma_f32_16x16x32_bf16 v[40:43], v[184:187], v[160:163], v[40:43]
    ds_read_b64_tr_b16 v[148:149], v17 offset:0
    v_mfma_f32_16x16x32_bf16 v[44:47], v[188:191], v[160:163], v[44:47]
    ds_read_b64_tr_b16 v[150:151], v17 offset:4096
    v_mfma_f32_16x16x32_bf16 v[48:51], v[176:179], v[164:167], v[48:51]
    ds_read_b128 v[136:139], v15 offset:0
    v_mfma_f32_16x16x32_bf16 v[52:55], v[180:183], v[164:167], v[52:55]
    ds_read_b64_tr_b16 v[152:153], v18 offset:0
    v_mfma_f32_16x16x32_bf16 v[56:59], v[184:187], v[164:167], v[56:59]
    ds_read_b64_tr_b16 v[154:155], v18 offset:4096
    v_mfma_f32_16x16x32_bf16 v[60:63], v[188:191], v[164:167], v[60:63]
    ds_read_b128 v[140:143], v15 offset:1024
    v_mfma_f32_16x16x32_bf16 v[64:67], v[176:179], v[168:171], v[64:67]
    ds_read_b64_tr_b16 v[156:157], v19 offset:0
    v_mfma_f32_16x16x32_bf16 v[68:71], v[180:183], v[168:171], v[68:71]
    ds_read_b64_tr_b16 v[158:159], v19 offset:4096
    v_mfma_f32_16x16x32_bf16 v[72:75], v[184:187], v[168:171], v[72:75]
    s_add_u32 s86, s86, 1
    v_mfma_f32_16x16x32_bf16 v[76:79], v[188:191], v[168:171], v[76:79]
    s_cmp_lt_u32 s86, 9
    v_mfma_f32_16x16x32_bf16 v[80:83], v[176:179], v[172:175], v[80:83]
    v_mfma_f32_16x16x32_bf16 v[84:87], v[180:183], v[172:175], v[84:87]
    v_mfma_f32_16x16x32_bf16 v[88:91], v[184:187], v[172:175], v[88:91]
    v_mfma_f32_16x16x32_bf16 v[92:95], v[188:191], v[172:175], v[92:95]
    s_cbranch_scc1 L_c_g2loop
    s_waitcnt lgkmcnt(0)
    v_mfma_f32_16x16x32_bf16 v[32:35], v[144:147], v[128:131], v[32:35]
    ds_read_b128 v[160:163], v14 offset:8192
    ds_read_b64_tr_b16 v[176:177], v16 offset:8192
    v_mfma_f32_16x16x32_bf16 v[36:39], v[148:151], v[128:131], v[36:39]
    ds_read_b64_tr_b16 v[178:179], v16 offset:12288
    ds_read_b128 v[164:167], v14 offset:9216
    v_mfma_f32_16x16x32_bf16 v[40:43], v[152:155], v[128:131], v[40:43]
    ds_read_b64_tr_b16 v[180:181], v17 offset:8192
    v_mfma_f32_16x16x32_bf16 v[44:47], v[156:159], v[128:131], v[44:47]
    ds_read_b64_tr_b16 v[182:183], v17 offset:12288
    v_mfma_f32_16x16x32_bf16 v[48:51], v[144:147], v[132:135], v[48:51]
    ds_read_b128 v[168:171], v15 offset:8192
    v_mfma_f32_16x16x32_bf16 v[52:55], v[148:151], v[132:135], v[52:55]
    ds_read_b64_tr_b16 v[184:185], v18 offset:8192
    v_mfma_f32_16x16x32_bf16 v[56:59], v[152:155], v[132:135], v[56:59]
    ds_read_b64_tr_b16 v[186:187], v18 offset:12288
    v_mfma_f32_16x16x32_bf16 v[60:63], v[156:159], v[132:135], v[60:63]
    ds_read_b128 v[172:175], v15 offset:9216
    v_mfma_f32_16x16x32_bf16 v[64:67], v[144:147], v[136:139], v[64:67]
    ds_read_b64_tr_b16 v[188:189], v19 offset:8192
    v_mfma_f32_16x16x32_bf16 v[68:71], v[148:151], v[136:139], v[68:71]
    ds_read_b64_tr_b16 v[190:191], v19 offset:12288
    v_mfma_f32_16x16x32_bf16 v[72:75], v[152:155], v[136:139], v[72:75]
    s_add_u32 s47, s47, 32768
    s_and_b32 s47, s47, 131071
    v_mfma_f32_16x16x32_bf16 v[76:79], v[156:159], v[136:139], v[76:79]
    v_add_u32 v14, s47, v2
    v_add_u32 v15, s47, v3
    v_mfma_f32_16x16x32_bf16 v[80:83], v[144:147], v[140:143], v[80:83]
    v_add_u32 v16, s47, v4
    v_add_u32 v17, s47, v5
    v_mfma_f32_16x16x32_bf16 v[84:87], v[148:151], v[140:143], v[84:87]
    v_add_u32 v18, s47, v6
    v_add_u32 v19, s47, v7
    v_mfma_f32_16x16x32_bf16 v[88:91], v[152:155], v[140:143], v[88:91]
    v_mfma_f32_16x16x32_bf16 v[92:95], v[156:159], v[140:143], v[92:95]
    s_waitcnt lgkmcnt(0)
    s_barrier
    v_mfma_f32_16x16x32_bf16 v[32:35], v[176:179], v[160:163], v[32:35]
    ds_read_b128 v[128:131], v14 offset:0
    ds_read_b64_tr_b16 v[144:145], v16 offset:0
    v_mfma_f32_16x16x32_bf16 v[36:39], v[180:183], v[160:163], v[36:39]
    ds_read_b64_tr_b16 v[146:147], v16 offset:4096
    ds_read_b128 v[132:135], v14 offset:1024
    v_mfma_f32_16x16x32_bf16 v[40:43], v[184:187], v[160:163], v[40:43]
    ds_read_b64_tr_b16 v[148:149], v17 offset:0
    v_mfma_f32_16x16x32_bf16 v[44:47], v[188:191], v[160:163], v[44:47]
    ds_read_b64_tr_b16 v[150:151], v17 offset:4096
    v_mfma_f32_16x16x32_bf16 v[48:51], v[176:179], v[164:167], v[48:51]
    ds_read_b64_tr_b16 v[152:153], v18 offset:0
    v_mfma_f32_16x16x32_bf16 v[52:55], v[180:183], v[164:167], v[52:55]
    ds_read_b64_tr_b16 v[154:155], v18 offset:4096
    v_mfma_f32_16x16x32_bf16 v[56:59], v[184:187], v[164:167], v[56:59]
    ds_read_b64_tr_b16 v[156:157], v19 offset:0
    v_mfma_f32_16x16x32_bf16 v[60:63], v[188:191], v[164:167], v[60:63]
    ds_read_b64_tr_b16 v[158:159], v19 offset:4096
    v_mfma_f32_16x16x32_bf16 v[64:67], v[176:179], v[168:171], v[64:67]
    v_mfma_f32_16x16x32_bf16 v[68:71], v[180:183], v[168:171], v[68:71]
    v_mfma_f32_16x16x32_bf16 v[72:75], v[184:187], v[168:171], v[72:75]
    v_mfma_f32_16x16x32_bf16 v[76:79], v[188:191], v[168:171], v[76:79]
    v_mfma_f32_16x16x32_bf16 v[80:83], v[176:179], v[172:175], v[80:83]
    v_mfma_f32_16x16x32_bf16 v[84:87], v[180:183], v[172:175], v[84:87]
    v_mfma_f32_16x16x32_bf16 v[88:91], v[184:187], v[172:175], v[88:91]
    v_mfma_f32_16x16x32_bf16 v[92:95], v[188:191], v[172:175], v[92:95]
    s_mov_b32 s60, 0xbfb8aa3b
    s_mov_b32 s61, s60
    s_waitcnt lgkmcnt(0)
    v_mfma_f32_16x16x32_bf16 v[96:99], v[144:147], v[128:131], 0
    ds_read_b128 v[160:163], v14 offset:8192
    ds_read_b64_tr_b16 v[176:177], v16 offset:8192
    v_mfma_f32_16x16x32_bf16 v[100:103], v[148:151], v[128:131], 0
    ds_read_b64_tr_b16 v[178:179], v16 offset:12288
    ds_read_b128 v[164:167], v14 offset:9216
    v_mfma_f32_16x16x32_bf16 v[104:107], v[152:155], v[128:131], 0
    ds_read_b64_tr_b16 v[180:181], v17 offset:8192
    ds_read_b64_tr_b16 v[182:183], v17 offset:12288
    v_mfma_f32_16x16x32_bf16 v[108:111], v[156:159], v[128:131], 0
    ds_read_b64_tr_b16 v[184:185], v18 offset:8192
    ds_read_b64_tr_b16 v[186:187], v18 offset:12288
    v_mfma_f32_16x16x32_bf16 v[112:115], v[144:147], v[132:135], 0
    ds_read_b64_tr_b16 v[188:189], v19 offset:8192
    ds_read_b64_tr_b16 v[190:191], v19 offset:12288
    v_mfma_f32_16x16x32_bf16 v[116:119], v[148:151], v[132:135], 0
    s_add_u32 s47, s47, 32768
    s_and_b32 s47, s47, 131071
    v_mfma_f32_16x16x32_bf16 v[120:123], v[152:155], v[132:135], 0
    v_add_u32 v14, s47, v2
    v_add_u32 v15, s47, v3
    v_mfma_f32_16x16x32_bf16 v[124:127], v[156:159], v[132:135], 0
    v_add_u32 v16, s47, v4
    v_add_u32 v17, s47, v5
    v_add_u32 v18, s47, v6
    v_add_u32 v19, s47, v7
    v_cvt_pk_bf16_f32 v64, v64, v65
    v_cvt_pk_bf16_f32 v65, v66, v67
    v_cvt_pk_bf16_f32 v66, v68, v69
    v_cvt_pk_bf16_f32 v67, v70, v71
    buffer_store_dwordx4 v[64:67], v240, s[32:35], s93 offen offset:0 sc1
    v_cvt_pk_bf16_f32 v68, v72, v73
    v_cvt_pk_bf16_f32 v69, v74, v75
    v_cvt_pk_bf16_f32 v70, v76, v77
    v_cvt_pk_bf16_f32 v71, v78, v79
    buffer_store_dwordx4 v[68:71], v240, s[32:35], s93 offen offset:1024 sc1
    v_cvt_pk_bf16_f32 v72, v80, v81
    v_cvt_pk_bf16_f32 v73, v82, v83
    v_cvt_pk_bf16_f32 v74, v84, v85
    v_cvt_pk_bf16_f32 v75, v86, v87
    buffer_store_dwordx4 v[72:75], v240, s[32:35], s93 offen offset:2048 sc1
    v_cvt_pk_bf16_f32 v76, v88, v89
    v_cvt_pk_bf16_f32 v77, v90, v91
    v_cvt_pk_bf16_f32 v78, v92, v93
    v_cvt_pk_bf16_f32 v79, v94, v95
    buffer_store_dwordx4 v[76:79], v240, s[32:35], s93 offen offset:3072 sc1
    s_waitcnt lgkmcnt(0)
    s_barrier
    v_mfma_f32_16x16x32_bf16 v[96:99], v[176:179], v[160:163], v[96:99]
    ds_read_b128 v[128:131], v14 offset:0
    ds_read_b64_tr_b16 v[144:145], v16 offset:0
    v_mfma_f32_16x16x32_bf16 v[100:103], v[180:183], v[160:163], v[100:103]
    ds_read_b64_tr_b16 v[146:147], v16 offset:4096
    ds_read_b128 v[132:135], v14 offset:1024
    v_mfma_f32_16x16x32_bf16 v[104:107], v[184:187], v[160:163], v[104:107]
    ds_read_b64_tr_b16 v[148:149], v17 offset:0
    ds_read_b64_tr_b16 v[150:151], v17 offset:4096
    v_mfma_f32_16x16x32_bf16 v[108:111], v[188:191], v[160:163], v[108:111]
    ds_read_b64_tr_b16 v[152:153], v18 offset:0
    ds_read_b64_tr_b16 v[154:155], v18 offset:4096
    v_mfma_f32_16x16x32_bf16 v[112:115], v[176:179], v[164:167], v[112:115]
    ds_read_b64_tr_b16 v[156:157], v19 offset:0
    ds_read_b64_tr_b16 v[158:159], v19 offset:4096
    v_mfma_f32_16x16x32_bf16 v[116:119], v[180:183], v[164:167], v[116:119]
    v_mfma_f32_16x16x32_bf16 v[120:123], v[184:187], v[164:167], v[120:123]
    v_mfma_f32_16x16x32_bf16 v[124:127], v[188:191], v[164:167], v[124:127]
    s_waitcnt lgkmcnt(0)
    v_mfma_f32_16x16x32_bf16 v[96:99], v[144:147], v[128:131], v[96:99]
    ds_read_b128 v[160:163], v14 offset:8192
    ds_read_b64_tr_b16 v[176:177], v16 offset:8192
    v_mfma_f32_16x16x32_bf16 v[100:103], v[148:151], v[128:131], v[100:103]
    ds_read_b64_tr_b16 v[178:179], v16 offset:12288
    ds_read_b128 v[164:167], v14 offset:9216
    v_mfma_f32_16x16x32_bf16 v[104:107], v[152:155], v[128:131], v[104:107]
    ds_read_b64_tr_b16 v[180:181], v17 offset:8192
    ds_read_b64_tr_b16 v[182:183], v17 offset:12288
    v_mfma_f32_16x16x32_bf16 v[108:111], v[156:159], v[128:131], v[108:111]
    ds_read_b64_tr_b16 v[184:185], v18 offset:8192
    ds_read_b64_tr_b16 v[186:187], v18 offset:12288
    v_mfma_f32_16x16x32_bf16 v[112:115], v[144:147], v[132:135], v[112:115]
    ds_read_b64_tr_b16 v[188:189], v19 offset:8192
    ds_read_b64_tr_b16 v[190:191], v19 offset:12288
    v_mfma_f32_16x16x32_bf16 v[116:119], v[148:151], v[132:135], v[116:119]
    s_add_u32 s47, s47, 32768
    s_and_b32 s47, s47, 131071
    v_mfma_f32_16x16x32_bf16 v[120:123], v[152:155], v[132:135], v[120:123]
    v_add_u32 v14, s47, v2
    v_add_u32 v15, s47, v3
    v_mfma_f32_16x16x32_bf16 v[124:127], v[156:159], v[132:135], v[124:127]
    v_add_u32 v16, s47, v4
    v_add_u32 v17, s47, v5
    v_add_u32 v18, s47, v6
    v_add_u32 v19, s47, v7
    s_waitcnt lgkmcnt(0)
    s_barrier
    v_mfma_f32_16x16x32_bf16 v[96:99], v[176:179], v[160:163], v[96:99]
    ds_read_b128 v[128:131], v14 offset:0
    ds_read_b64_tr_b16 v[144:145], v16 offset:0
    v_mfma_f32_16x16x32_bf16 v[100:103], v[180:183], v[160:163], v[100:103]
    ds_read_b64_tr_b16 v[146:147], v16 offset:4096
    ds_read_b128 v[132:135], v14 offset:1024
    v_mfma_f32_16x16x32_bf16 v[104:107], v[184:187], v[160:163], v[104:107]
    ds_read_b64_tr_b16 v[148:149], v17 offset:0
    ds_read_b64_tr_b16 v[150:151], v17 offset:4096
    v_mfma_f32_16x16x32_bf16 v[108:111], v[188:191], v[160:163], v[108:111]
    ds_read_b64_tr_b16 v[152:153], v18 offset:0
    ds_read_b64_tr_b16 v[154:155], v18 offset:4096
    v_mfma_f32_16x16x32_bf16 v[112:115], v[176:179], v[164:167], v[112:115]
    ds_read_b64_tr_b16 v[156:157], v19 offset:0
    ds_read_b64_tr_b16 v[158:159], v19 offset:4096
    v_mfma_f32_16x16x32_bf16 v[116:119], v[180:183], v[164:167], v[116:119]
    v_mfma_f32_16x16x32_bf16 v[120:123], v[184:187], v[164:167], v[120:123]
    v_mfma_f32_16x16x32_bf16 v[124:127], v[188:191], v[164:167], v[124:127]
    s_waitcnt lgkmcnt(0)
    v_mfma_f32_16x16x32_bf16 v[96:99], v[144:147], v[128:131], v[96:99]
    ds_read_b128 v[160:163], v14 offset:8192
    ds_read_b64_tr_b16 v[176:177], v16 offset:8192
    v_mfma_f32_16x16x32_bf16 v[100:103], v[148:151], v[128:131], v[100:103]
    ds_read_b64_tr_b16 v[178:179], v16 offset:12288
    ds_read_b128 v[164:167], v14 offset:9216
    v_mfma_f32_16x16x32_bf16 v[104:107], v[152:155], v[128:131], v[104:107]
    ds_read_b64_tr_b16 v[180:181], v17 offset:8192
    ds_read_b64_tr_b16 v[182:183], v17 offset:12288
    v_mfma_f32_16x16x32_bf16 v[108:111], v[156:159], v[128:131], v[108:111]
    ds_read_b64_tr_b16 v[184:185], v18 offset:8192
    ds_read_b64_tr_b16 v[186:187], v18 offset:12288
    v_mfma_f32_16x16x32_bf16 v[112:115], v[144:147], v[132:135], v[112:115]
    ds_read_b64_tr_b16 v[188:189], v19 offset:8192
    ds_read_b64_tr_b16 v[190:191], v19 offset:12288
    v_mfma_f32_16x16x32_bf16 v[116:119], v[148:151], v[132:135], v[116:119]
    s_add_u32 s47, s47, 32768
    s_and_b32 s47, s47, 131071
    v_mfma_f32_16x16x32_bf16 v[120:123], v[152:155], v[132:135], v[120:123]
    v_add_u32 v14, s47, v2
    v_add_u32 v15, s47, v3
    v_mfma_f32_16x16x32_bf16 v[124:127], v[156:159], v[132:135], v[124:127]
    v_add_u32 v16, s47, v4
    v_add_u32 v17, s47, v5
    v_add_u32 v18, s47, v6
    v_add_u32 v19, s47, v7
    s_waitcnt vmcnt(0)
    s_mov_b64 exec, 1
    buffer_store_dword v241, v20, s[32:35], s80 offen sc1
    s_mov_b64 exec, -1
    s_waitcnt lgkmcnt(0)
    s_barrier
    v_mfma_f32_16x16x32_bf16 v[96:99], v[176:179], v[160:163], v[96:99]
    ds_read_b128 v[128:131], v14 offset:0
    ds_read_b64_tr_b16 v[144:145], v16 offset:0
    v_mfma_f32_16x16x32_bf16 v[100:103], v[180:183], v[160:163], v[100:103]
    ds_read_b64_tr_b16 v[146:147], v16 offset:4096
    ds_read_b128 v[132:135], v14 offset:1024
    v_mfma_f32_16x16x32_bf16 v[104:107], v[184:187], v[160:163], v[104:107]
    ds_read_b64_tr_b16 v[148:149], v17 offset:0
    ds_read_b64_tr_b16 v[150:151], v17 offset:4096
    v_mfma_f32_16x16x32_bf16 v[108:111], v[188:191], v[160:163], v[108:111]
    ds_read_b64_tr_b16 v[152:153], v18 offset:0
    ds_read_b64_tr_b16 v[154:155], v18 offset:4096
    v_mfma_f32_16x16x32_bf16 v[112:115], v[176:179], v[164:167], v[112:115]
    ds_read_b64_tr_b16 v[156:157], v19 offset:0
    ds_read_b64_tr_b16 v[158:159], v19 offset:4096
    v_mfma_f32_16x16x32_bf16 v[116:119], v[180:183], v[164:167], v[116:119]
    v_mfma_f32_16x16x32_bf16 v[120:123], v[184:187], v[164:167], v[120:123]
    v_mfma_f32_16x16x32_bf16 v[124:127], v[188:191], v[164:167], v[124:127]
    s_waitcnt lgkmcnt(0)
    v_mfma_f32_16x16x32_bf16 v[96:99], v[144:147], v[128:131], v[96:99]
    ds_read_b128 v[160:163], v14 offset:8192
    ds_read_b64_tr_b16 v[176:177], v16 offset:8192
    v_mfma_f32_16x16x32_bf16 v[100:103], v[148:151], v[128:131], v[100:103]
    ds_read_b64_tr_b16 v[178:179], v16 offset:12288
    ds_read_b128 v[164:167], v14 offset:9216
    v_mfma_f32_16x16x32_bf16 v[104:107], v[152:155], v[128:131], v[104:107]
    ds_read_b64_tr_b16 v[180:181], v17 offset:8192
    ds_read_b64_tr_b16 v[182:183], v17 offset:12288
    v_mfma_f32_16x16x32_bf16 v[108:111], v[156:159], v[128:131], v[108:111]
    ds_read_b64_tr_b16 v[184:185], v18 offset:8192
    ds_read_b64_tr_b16 v[186:187], v18 offset:12288
    v_mfma_f32_16x16x32_bf16 v[112:115], v[144:147], v[132:135], v[112:115]
    ds_read_b64_tr_b16 v[188:189], v19 offset:8192
    ds_read_b64_tr_b16 v[190:191], v19 offset:12288
    v_mfma_f32_16x16x32_bf16 v[116:119], v[148:151], v[132:135], v[116:119]
    s_add_u32 s47, s47, 32768
    s_and_b32 s47, s47, 131071
    v_mfma_f32_16x16x32_bf16 v[120:123], v[152:155], v[132:135], v[120:123]
    v_add_u32 v14, s47, v2
    v_add_u32 v15, s47, v3
    v_mfma_f32_16x16x32_bf16 v[124:127], v[156:159], v[132:135], v[124:127]
    v_add_u32 v16, s47, v4
    v_add_u32 v17, s47, v5
    v_add_u32 v18, s47, v6
    v_add_u32 v19, s47, v7
    s_waitcnt lgkmcnt(0)
    s_barrier
    v_mfma_f32_16x16x32_bf16 v[96:99], v[176:179], v[160:163], v[96:99]
    ds_read_b128 v[128:131], v14 offset:0
    ds_read_b64_tr_b16 v[144:145], v16 offset:0
    v_mfma_f32_16x16x32_bf16 v[100:103], v[180:183], v[160:163], v[100:103]
    ds_read_b64_tr_b16 v[146:147], v16 offset:4096
    ds_read_b128 v[132:135], v14 offset:1024
    v_mfma_f32_16x16x32_bf16 v[104:107], v[184:187], v[160:163], v[104:107]
    ds_read_b64_tr_b16 v[148:149], v17 offset:0
    ds_read_b64_tr_b16 v[150:151], v17 offset:4096
    v_mfma_f32_16x16x32_bf16 v[108:111], v[188:191], v[160:163], v[108:111]
    ds_read_b64_tr_b16 v[152:153], v18 offset:0
    ds_read_b64_tr_b16 v[154:155], v18 offset:4096
    v_mfma_f32_16x16x32_bf16 v[112:115], v[176:179], v[164:167], v[112:115]
    ds_read_b64_tr_b16 v[156:157], v19 offset:0
    ds_read_b64_tr_b16 v[158:159], v19 offset:4096
    v_mfma_f32_16x16x32_bf16 v[116:119], v[180:183], v[164:167], v[116:119]
    v_mfma_f32_16x16x32_bf16 v[120:123], v[184:187], v[164:167], v[120:123]
    v_mfma_f32_16x16x32_bf16 v[124:127], v[188:191], v[164:167], v[124:127]
    s_waitcnt lgkmcnt(0)
    v_mfma_f32_16x16x32_bf16 v[96:99], v[144:147], v[128:131], v[96:99]
    ds_read_b128 v[160:163], v14 offset:8192
    ds_read_b64_tr_b16 v[176:177], v16 offset:8192
    v_mfma_f32_16x16x32_bf16 v[100:103], v[148:151], v[128:131], v[100:103]
    ds_read_b64_tr_b16 v[178:179], v16 offset:12288
    ds_read_b128 v[164:167], v14 offset:9216
    v_mfma_f32_16x16x32_bf16 v[104:107], v[152:155], v[128:131], v[104:107]
    ds_read_b64_tr_b16 v[180:181], v17 offset:8192
    ds_read_b64_tr_b16 v[182:183], v17 offset:12288
    v_mfma_f32_16x16x32_bf16 v[108:111], v[156:159], v[128:131], v[108:111]
    ds_read_b64_tr_b16 v[184:185], v18 offset:8192
    ds_read_b64_tr_b16 v[186:187], v18 offset:12288
    v_mfma_f32_16x16x32_bf16 v[112:115], v[144:147], v[132:135], v[112:115]
    ds_read_b64_tr_b16 v[188:189], v19 offset:8192
    ds_read_b64_tr_b16 v[190:191], v19 offset:12288
    v_mfma_f32_16x16x32_bf16 v[116:119], v[148:151], v[132:135], v[116:119]
    s_add_u32 s47, s47, 32768
    s_and_b32 s47, s47, 131071
    v_mfma_f32_16x16x32_bf16 v[120:123], v[152:155], v[132:135], v[120:123]
    v_add_u32 v14, s47, v2
    v_add_u32 v15, s47, v3
    v_mfma_f32_16x16x32_bf16 v[124:127], v[156:159], v[132:135], v[124:127]
    v_add_u32 v16, s47, v4
    v_add_u32 v17, s47, v5
    v_add_u32 v18, s47, v6
    v_add_u32 v19, s47, v7
    s_waitcnt lgkmcnt(0)
    s_barrier
    v_mfma_f32_16x16x32_bf16 v[96:99], v[176:179], v[160:163], v[96:99]
    ds_read_b128 v[128:131], v14 offset:0
    ds_read_b64_tr_b16 v[144:145], v16 offset:0
    v_mfma_f32_16x16x32_bf16 v[100:103], v[180:183], v[160:163], v[100:103]
    ds_read_b64_tr_b16 v[146:147], v16 offset:4096
    ds_read_b128 v[132:135], v14 offset:1024
    v_mfma_f32_16x16x32_bf16 v[104:107], v[184:187], v[160:163], v[104:107]
    ds_read_b64_tr_b16 v[148:149], v17 offset:0
    ds_read_b64_tr_b16 v[150:151], v17 offset:4096
    v_mfma_f32_16x16x32_bf16 v[108:111], v[188:191], v[160:163], v[108:111]
    ds_read_b64_tr_b16 v[152:153], v18 offset:0
    ds_read_b64_tr_b16 v[154:155], v18 offset:4096
    v_mfma_f32_16x16x32_bf16 v[112:115], v[176:179], v[164:167], v[112:115]
    ds_read_b64_tr_b16 v[156:157], v19 offset:0
    ds_read_b64_tr_b16 v[158:159], v19 offset:4096
    v_mfma_f32_16x16x32_bf16 v[116:119], v[180:183], v[164:167], v[116:119]
    v_mfma_f32_16x16x32_bf16 v[120:123], v[184:187], v[164:167], v[120:123]
    v_mfma_f32_16x16x32_bf16 v[124:127], v[188:191], v[164:167], v[124:127]
    s_waitcnt lgkmcnt(0)
    v_mfma_f32_16x16x32_bf16 v[96:99], v[144:147], v[128:131], v[96:99]
    ds_read_b128 v[160:163], v14 offset:8192
    ds_read_b64_tr_b16 v[176:177], v16 offset:8192
    v_mfma_f32_16x16x32_bf16 v[100:103], v[148:151], v[128:131], v[100:103]
    ds_read_b64_tr_b16 v[178:179], v16 offset:12288
    ds_read_b128 v[164:167], v14 offset:9216
    v_mfma_f32_16x16x32_bf16 v[104:107], v[152:155], v[128:131], v[104:107]
    ds_read_b64_tr_b16 v[180:181], v17 offset:8192
    ds_read_b64_tr_b16 v[182:183], v17 offset:12288
    v_mfma_f32_16x16x32_bf16 v[108:111], v[156:159], v[128:131], v[108:111]
    ds_read_b64_tr_b16 v[184:185], v18 offset:8192
    ds_read_b64_tr_b16 v[186:187], v18 offset:12288
    v_mfma_f32_16x16x32_bf16 v[112:115], v[144:147], v[132:135], v[112:115]
    ds_read_b64_tr_b16 v[188:189], v19 offset:8192
    ds_read_b64_tr_b16 v[190:191], v19 offset:12288
    v_mfma_f32_16x16x32_bf16 v[116:119], v[148:151], v[132:135], v[116:119]
    s_add_u32 s47, s47, 32768
    s_and_b32 s47, s47, 131071
    v_mfma_f32_16x16x32_bf16 v[120:123], v[152:155], v[132:135], v[120:123]
    v_add_u32 v14, s47, v2
    v_add_u32 v15, s47, v3
    v_mfma_f32_16x16x32_bf16 v[124:127], v[156:159], v[132:135], v[124:127]
    v_add_u32 v16, s47, v4
    v_add_u32 v17, s47, v5
    v_add_u32 v18, s47, v6
    v_add_u32 v19, s47, v7
    s_waitcnt lgkmcnt(0)
    s_barrier
    v_mfma_f32_16x16x32_bf16 v[96:99], v[176:179], v[160:163], v[96:99]
    ds_read_b128 v[128:131], v14 offset:0
    ds_read_b64_tr_b16 v[144:145], v16 offset:0
    v_mfma_f32_16x16x32_bf16 v[100:103], v[180:183], v[160:163], v[100:103]
    ds_read_b64_tr_b16 v[146:147], v16 offset:4096
    ds_read_b128 v[132:135], v14 offset:1024
    v_mfma_f32_16x16x32_bf16 v[104:107], v[184:187], v[160:163], v[104:107]
    ds_read_b64_tr_b16 v[148:149], v17 offset:0
    ds_read_b64_tr_b16 v[150:151], v17 offset:4096
    v_mfma_f32_16x16x32_bf16 v[108:111], v[188:191], v[160:163], v[108:111]
    ds_read_b64_tr_b16 v[152:153], v18 offset:0
    ds_read_b64_tr_b16 v[154:155], v18 offset:4096
    v_mfma_f32_16x16x32_bf16 v[112:115], v[176:179], v[164:167], v[112:115]
    ds_read_b64_tr_b16 v[156:157], v19 offset:0
    ds_read_b64_tr_b16 v[158:159], v19 offset:4096
    v_mfma_f32_16x16x32_bf16 v[116:119], v[180:183], v[164:167], v[116:119]
    buffer_load_dword v22, v20, s[32:35], s81 offen sc1
    v_mfma_f32_16x16x32_bf16 v[120:123], v[184:187], v[164:167], v[120:123]
    v_mfma_f32_16x16x32_bf16 v[124:127], v[188:191], v[164:167], v[124:127]
    s_waitcnt vmcnt(0)
    s_mov_b32 s73, 0
    v_readfirstlane_b32 s62, v22
    s_nop 0
    s_cmp_eq_u32 s62, s96
    s_cbranch_scc1 xp_done_18
xp_spin_17:
    buffer_load_dword v22, v20, s[32:35], s81 offen sc1
    s_waitcnt vmcnt(0)
    v_readfirstlane_b32 s62, v22
    s_nop 0
    s_cmp_eq_u32 s62, s96
    s_cbranch_scc1 xp_done_18
    s_sleep 1
    s_add_u32 s73, s73, 1
    s_cmp_lt_u32 s73, 0x8000
    s_cbranch_scc1 xp_spin_17
xp_done_18:
    s_waitcnt lgkmcnt(0)
    v_mfma_f32_16x16x32_bf16 v[96:99], v[144:147], v[128:131], v[96:99]
    ds_read_b128 v[160:163], v14 offset:8192
    ds_read_b64_tr_b16 v[176:177], v16 offset:8192
    v_mfma_f32_16x16x32_bf16 v[100:103], v[148:151], v[128:131], v[100:103]
    ds_read_b64_tr_b16 v[178:179], v16 offset:12288
    ds_read_b128 v[164:167], v14 offset:9216
    v_mfma_f32_16x16x32_bf16 v[104:107], v[152:155], v[128:131], v[104:107]
    ds_read_b64_tr_b16 v[180:181], v17 offset:8192
    ds_read_b64_tr_b16 v[182:183], v17 offset:12288
    v_mfma_f32_16x16x32_bf16 v[108:111], v[156:159], v[128:131], v[108:111]
    ds_read_b64_tr_b16 v[184:185], v18 offset:8192
    ds_read_b64_tr_b16 v[186:187], v18 offset:12288
    v_mfma_f32_16x16x32_bf16 v[112:115], v[144:147], v[132:135], v[112:115]
    ds_read_b64_tr_b16 v[188:189], v19 offset:8192
    ds_read_b64_tr_b16 v[190:191], v19 offset:12288
    v_mfma_f32_16x16x32_bf16 v[116:119], v[148:151], v[132:135], v[116:119]
    s_add_u32 s47, s47, 32768
    s_and_b32 s47, s47, 131071
    v_mfma_f32_16x16x32_bf16 v[120:123], v[152:155], v[132:135], v[120:123]
    v_add_u32 v14, s47, v2
    v_add_u32 v15, s47, v3
    v_mfma_f32_16x16x32_bf16 v[124:127], v[156:159], v[132:135], v[124:127]
    v_add_u32 v16, s47, v4
    v_add_u32 v17, s47, v5
    v_add_u32 v18, s47, v6
    v_add_u32 v19, s47, v7
    buffer_load_dwordx4 v[80:83], v240, s[32:35], s94 offen offset:0 sc1
    buffer_load_dwordx4 v[84:87], v240, s[32:35], s94 offen offset:1024 sc1
    buffer_load_dwordx4 v[88:91], v240, s[32:35], s94 offen offset:2048 sc1
    buffer_load_dwordx4 v[92:95], v240, s[32:35], s94 offen offset:3072 sc1
    s_waitcnt lgkmcnt(0)
    s_barrier
    v_mfma_f32_16x16x32_bf16 v[96:99], v[176:179], v[160:163], v[96:99]
    ds_read_b128 v[128:131], v14 offset:0
    ds_read_b64_tr_b16 v[144:145], v16 offset:0
    v_mfma_f32_16x16x32_bf16 v[100:103], v[180:183], v[160:163], v[100:103]
    ds_read_b64_tr_b16 v[146:147], v16 offset:4096
    ds_read_b128 v[132:135], v14 offset:1024
    v_mfma_f32_16x16x32_bf16 v[104:107], v[184:187], v[160:163], v[104:107]
    ds_read_b64_tr_b16 v[148:149], v17 offset:0
    ds_read_b64_tr_b16 v[150:151], v17 offset:4096
    v_mfma_f32_16x16x32_bf16 v[108:111], v[188:191], v[160:163], v[108:111]
    ds_read_b64_tr_b16 v[152:153], v18 offset:0
    ds_read_b64_tr_b16 v[154:155], v18 offset:4096
    v_mfma_f32_16x16x32_bf16 v[112:115], v[176:179], v[164:167], v[112:115]
    ds_read_b64_tr_b16 v[156:157], v19 offset:0
    ds_read_b64_tr_b16 v[158:159], v19 offset:4096
    v_mfma_f32_16x16x32_bf16 v[116:119], v[180:183], v[164:167], v[116:119]
    v_mfma_f32_16x16x32_bf16 v[120:123], v[184:187], v[164:167], v[120:123]
    v_mfma_f32_16x16x32_bf16 v[124:127], v[188:191], v[164:167], v[124:127]
    s_waitcnt lgkmcnt(0)
    v_mfma_f32_16x16x32_bf16 v[96:99], v[144:147], v[128:131], v[96:99]
    ds_read_b128 v[160:163], v14 offset:8192
    ds_read_b64_tr_b16 v[176:177], v16 offset:8192
    v_mfma_f32_16x16x32_bf16 v[100:103], v[148:151], v[128:131], v[100:103]
    ds_read_b64_tr_b16 v[178:179], v16 offset:12288
    ds_read_b128 v[164:167], v14 offset:9216
    v_mfma_f32_16x16x32_bf16 v[104:107], v[152:155], v[128:131], v[104:107]
    ds_read_b64_tr_b16 v[180:181], v17 offset:8192
    ds_read_b64_tr_b16 v[182:183], v17 offset:12288
    v_mfma_f32_16x16x32_bf16 v[108:111], v[156:159], v[128:131], v[108:111]
    ds_read_b64_tr_b16 v[184:185], v18 offset:8192
    ds_read_b64_tr_b16 v[186:187], v18 offset:12288
    v_mfma_f32_16x16x32_bf16 v[112:115], v[144:147], v[132:135], v[112:115]
    ds_read_b64_tr_b16 v[188:189], v19 offset:8192
    ds_read_b64_tr_b16 v[190:191], v19 offset:12288
    v_mfma_f32_16x16x32_bf16 v[116:119], v[148:151], v[132:135], v[116:119]
    v_mfma_f32_16x16x32_bf16 v[120:123], v[152:155], v[132:135], v[120:123]
    v_mfma_f32_16x16x32_bf16 v[124:127], v[156:159], v[132:135], v[124:127]
    s_waitcnt lgkmcnt(0)
    v_mfma_f32_16x16x32_bf16 v[96:99], v[176:179], v[160:163], v[96:99]
    v_mfma_f32_16x16x32_bf16 v[100:103], v[180:183], v[160:163], v[100:103]
    v_mfma_f32_16x16x32_bf16 v[104:107], v[184:187], v[160:163], v[104:107]
    v_mfma_f32_16x16x32_bf16 v[108:111], v[188:191], v[160:163], v[108:111]
    v_mfma_f32_16x16x32_bf16 v[112:115], v[176:179], v[164:167], v[112:115]
    v_mfma_f32_16x16x32_bf16 v[116:119], v[180:183], v[164:167], v[116:119]
    v_mfma_f32_16x16x32_bf16 v[120:123], v[184:187], v[164:167], v[120:123]
    v_mfma_f32_16x16x32_bf16 v[124:127], v[188:191], v[164:167], v[124:127]
    s_setprio 0
    s_waitcnt vmcnt(3)
    v_lshlrev_b32 v144, 16, v80
    v_and_b32 v145, 0xffff0000, v80
    v_lshlrev_b32 v146, 16, v81
    v_and_b32 v147, 0xffff0000, v81
    v_lshlrev_b32 v148, 16, v82
    v_and_b32 v149, 0xffff0000, v82
    v_lshlrev_b32 v150, 16, v83
    v_and_b32 v151, 0xffff0000, v83
    v_pk_add_f32 v[32:33], v[32:33], v[144:145]
    v_pk_add_f32 v[34:35], v[34:35], v[146:147]
    v_pk_add_f32 v[36:37], v[36:37], v[148:149]
    v_pk_add_f32 v[38:39], v[38:39], v[150:151]
    s_waitcnt vmcnt(2)
    v_lshlrev_b32 v144, 16, v84
    v_and_b32 v145, 0xffff0000, v84
    v_lshlrev_b32 v146, 16, v85
    v_and_b32 v147, 0xffff0000, v85
    v_lshlrev_b32 v148, 16, v86
    v_and_b32 v149, 0xffff0000, v86
    v_lshlrev_b32 v150, 16, v87
    v_and_b32 v151, 0xffff0000, v87
    v_pk_add_f32 v[40:41], v[40:41], v[144:145]
    v_pk_add_f32 v[42:43], v[42:43], v[146:147]
    v_pk_add_f32 v[44:45], v[44:45], v[148:149]
    v_pk_add_f32 v[46:47], v[46:47], v[150:151]
    s_waitcnt vmcnt(1)
    v_lshlrev_b32 v144, 16, v88
    v_and_b32 v145, 0xffff0000, v88
    v_lshlrev_b32 v146, 16, v89
    v_and_b32 v147, 0xffff0000, v89
    v_lshlrev_b32 v148, 16, v90
    v_and_b32 v149, 0xffff0000, v90
    v_lshlrev_b32 v150, 16, v91
    v_and_b32 v151, 0xffff0000, v91
    v_pk_add_f32 v[48:49], v[48:49], v[144:145]
    v_pk_add_f32 v[50:51], v[50:51], v[146:147]
    v_pk_add_f32 v[52:53], v[52:53], v[148:149]
    v_pk_add_f32 v[54:55], v[54:55], v[150:151]
    s_waitcnt vmcnt(0)
    v_lshlrev_b32 v144, 16, v92
    v_and_b32 v145, 0xffff0000, v92
    v_lshlrev_b32 v146, 16, v93
    v_and_b32 v147, 0xffff0000, v93
    v_lshlrev_b32 v148, 16, v94
    v_and_b32 v149, 0xffff0000, v94
    v_lshlrev_b32 v150, 16, v95
    v_and_b32 v151, 0xffff0000, v95
    v_pk_add_f32 v[56:57], v[56:57], v[144:145]
    v_pk_add_f32 v[58:59], v[58:59], v[146:147]
    v_pk_add_f32 v[60:61], v[60:61], v[148:149]
    v_pk_add_f32 v[62:63], v[62:63], v[150:151]
    v_pk_mul_f32 v[128:129], v[32:33], s[60:61]
    v_pk_mul_f32 v[130:131], v[34:35], s[60:61]
    v_pk_mul_f32 v[132:133], v[36:37], s[60:61]
    v_pk_mul_f32 v[134:135], v[38:39], s[60:61]
    v_pk_mul_f32 v[136:137], v[40:41], s[60:61]
    v_pk_mul_f32 v[138:139], v[42:43], s[60:61]
    v_pk_mul_f32 v[140:141], v[44:45], s[60:61]
    v_pk_mul_f32 v[142:143], v[46:47], s[60:61]
    v_exp_f32 v128, v128
    v_exp_f32 v129, v129
    v_exp_f32 v130, v130
    v_exp_f32 v131, v131
    v_exp_f32 v132, v132
    v_exp_f32 v133, v133
    v_exp_f32 v134, v134
    v_exp_f32 v135, v135
    v_exp_f32 v136, v136
    v_exp_f32 v137, v137
    v_exp_f32 v138, v138
    v_exp_f32 v139, v139
    v_exp_f32 v140, v140
    v_exp_f32 v141, v141
    v_exp_f32 v142, v142
    v_exp_f32 v143, v143
    v_pk_add_f32 v[128:129], v[128:129], 1.0 op_sel_hi:[1,0]
    v_pk_add_f32 v[130:131], v[130:131], 1.0 op_sel_hi:[1,0]
    v_pk_add_f32 v[132:133], v[132:133], 1.0 op_sel_hi:[1,0]
    v_pk_add_f32 v[134:135], v[134:135], 1.0 op_sel_hi:[1,0]
    v_pk_add_f32 v[136:137], v[136:137], 1.0 op_sel_hi:[1,0]
    v_pk_add_f32 v[138:139], v[138:139], 1.0 op_sel_hi:[1,0]
    v_pk_add_f32 v[140:141], v[140:141], 1.0 op_sel_hi:[1,0]
    v_pk_add_f32 v[142:143], v[142:143], 1.0 op_sel_hi:[1,0]
    v_rcp_f32 v128, v128
    v_rcp_f32 v129, v129
    v_rcp_f32 v130, v130
    v_rcp_f32 v131, v131
    v_rcp_f32 v132, v132
    v_rcp_f32 v133, v133
    v_rcp_f32 v134, v134
    v_rcp_f32 v135, v135
    v_rcp_f32 v136, v136
    v_rcp_f32 v137, v137
    v_rcp_f32 v138, v138
    v_rcp_f32 v139, v139
    v_rcp_f32 v140, v140
    v_rcp_f32 v141, v141
    v_rcp_f32 v142, v142
    v_rcp_f32 v143, v143
    v_pk_mul_f32 v[32:33], v[32:33], v[96:97]
    v_pk_mul_f32 v[34:35], v[34:35], v[98:99]
    v_pk_mul_f32 v[36:37], v[36:37], v[100:101]
    v_pk_mul_f32 v[38:39], v[38:39], v[102:103]
    v_pk_mul_f32 v[40:41], v[40:41], v[104:105]
    v_pk_mul_f32 v[42:43], v[42:43], v[106:107]
    v_pk_mul_f32 v[44:45], v[44:45], v[108:109]
    v_pk_mul_f32 v[46:47], v[46:47], v[110:111]
    v_pk_fma_f32 v[128:129], v[128:129], v[32:33], v[192:193]
    v_pk_fma_f32 v[130:131], v[130:131], v[34:35], v[194:195]
    v_pk_fma_f32 v[132:133], v[132:133], v[36:37], v[196:197]
    v_pk_fma_f32 v[134:135], v[134:135], v[38:39], v[198:199]
    v_pk_fma_f32 v[136:137], v[136:137], v[40:41], v[200:201]
    v_pk_fma_f32 v[138:139], v[138:139], v[42:43], v[202:203]
    v_pk_fma_f32 v[140:141], v[140:141], v[44:45], v[204:205]
    v_pk_fma_f32 v[142:143], v[142:143], v[46:47], v[206:207]
    v_cvt_pk_bf16_f32 v160, v128, v129
    v_cvt_pk_bf16_f32 v161, v130, v131
    v_cvt_pk_bf16_f32 v162, v132, v133
    v_cvt_pk_bf16_f32 v163, v134, v135
    v_cvt_pk_bf16_f32 v164, v136, v137
    v_cvt_pk_bf16_f32 v165, v138, v139
    v_cvt_pk_bf16_f32 v166, v140, v141
    v_cvt_pk_bf16_f32 v167, v142, v143
    s_nop 1
    v_permlane16_swap_b32 v160, v162
    v_permlane16_swap_b32 v161, v163
    v_permlane16_swap_b32 v164, v166
    v_permlane16_swap_b32 v165, v167
    buffer_store_dwordx4 v[160:163], v9, s[16:19], s91 offen offset:0
    buffer_store_dwordx4 v[164:167], v9, s[16:19], s91 offen offset:64
    v_pk_mul_f32 v[128:129], v[48:49], s[60:61]
    v_pk_mul_f32 v[130:131], v[50:51], s[60:61]
    v_pk_mul_f32 v[132:133], v[52:53], s[60:61]
    v_pk_mul_f32 v[134:135], v[54:55], s[60:61]
    v_pk_mul_f32 v[136:137], v[56:57], s[60:61]
    v_pk_mul_f32 v[138:139], v[58:59], s[60:61]
    v_pk_mul_f32 v[140:141], v[60:61], s[60:61]
    v_pk_mul_f32 v[142:143], v[62:63], s[60:61]
    v_exp_f32 v128, v128
    v_exp_f32 v129, v129
    v_exp_f32 v130, v130
    v_exp_f32 v131, v131
    v_exp_f32 v132, v132
    v_exp_f32 v133, v133
    v_exp_f32 v134, v134
    v_exp_f32 v135, v135
    v_exp_f32 v136, v136
    v_exp_f32 v137, v137
    v_exp_f32 v138, v138
    v_exp_f32 v139, v139
    v_exp_f32 v140, v140
    v_exp_f32 v141, v141
    v_exp_f32 v142, v142
    v_exp_f32 v143, v143
    v_pk_add_f32 v[128:129], v[128:129], 1.0 op_sel_hi:[1,0]
    v_pk_add_f32 v[130:131], v[130:131], 1.0 op_sel_hi:[1,0]
    v_pk_add_f32 v[132:133], v[132:133], 1.0 op_sel_hi:[1,0]
    v_pk_add_f32 v[134:135], v[134:135], 1.0 op_sel_hi:[1,0]
    v_pk_add_f32 v[136:137], v[136:137], 1.0 op_sel_hi:[1,0]
    v_pk_add_f32 v[138:139], v[138:139], 1.0 op_sel_hi:[1,0]
    v_pk_add_f32 v[140:141], v[140:141], 1.0 op_sel_hi:[1,0]
    v_pk_add_f32 v[142:143], v[142:143], 1.0 op_sel_hi:[1,0]
    v_rcp_f32 v128, v128
    v_rcp_f32 v129, v129
    v_rcp_f32 v130, v130
    v_rcp_f32 v131, v131
    v_rcp_f32 v132, v132
    v_rcp_f32 v133, v133
    v_rcp_f32 v134, v134
    v_rcp_f32 v135, v135
    v_rcp_f32 v136, v136
    v_rcp_f32 v137, v137
    v_rcp_f32 v138, v138
    v_rcp_f32 v139, v139
    v_rcp_f32 v140, v140
    v_rcp_f32 v141, v141
    v_rcp_f32 v142, v142
    v_rcp_f32 v143, v143
    v_pk_mul_f32 v[48:49], v[48:49], v[112:113]
    v_pk_mul_f32 v[50:51], v[50:51], v[114:115]
    v_pk_mul_f32 v[52:53], v[52:53], v[116:117]
    v_pk_mul_f32 v[54:55], v[54:55], v[118:119]
    v_pk_mul_f32 v[56:57], v[56:57], v[120:121]
    v_pk_mul_f32 v[58:59], v[58:59], v[122:123]
    v_pk_mul_f32 v[60:61], v[60:61], v[124:125]
    v_pk_mul_f32 v[62:63], v[62:63], v[126:127]
    v_pk_fma_f32 v[128:129], v[128:129], v[48:49], v[208:209]
    v_pk_fma_f32 v[130:131], v[130:131], v[50:51], v[210:211]
    v_pk_fma_f32 v[132:133], v[132:133], v[52:53], v[212:213]
    v_pk_fma_f32 v[134:135], v[134:135], v[54:55], v[214:215]
    v_pk_fma_f32 v[136:137], v[136:137], v[56:57], v[216:217]
    v_pk_fma_f32 v[138:139], v[138:139], v[58:59], v[218:219]
    v_pk_fma_f32 v[140:141], v[140:141], v[60:61], v[220:221]
    v_pk_fma_f32 v[142:143], v[142:143], v[62:63], v[222:223]
    v_cvt_pk_bf16_f32 v168, v128, v129
    v_cvt_pk_bf16_f32 v169, v130, v131
    v_cvt_pk_bf16_f32 v170, v132, v133
    v_cvt_pk_bf16_f32 v171, v134, v135
    v_cvt_pk_bf16_f32 v172, v136, v137
    v_cvt_pk_bf16_f32 v173, v138, v139
    v_cvt_pk_bf16_f32 v174, v140, v141
    v_cvt_pk_bf16_f32 v175, v142, v143
    s_nop 1
    v_permlane16_swap_b32 v168, v170
    v_permlane16_swap_b32 v169, v171
    v_permlane16_swap_b32 v172, v174
    v_permlane16_swap_b32 v173, v175
    buffer_store_dwordx4 v[168:171], v9, s[16:19], s92 offen offset:0
    buffer_store_dwordx4 v[172:175], v9, s[16:19], s92 offen offset:64
    s_endpgm
L_cs0:
    v_mov_b32 v10, 0x3f803f80
    v_mov_b32 v11, 0x3f803f80
    v_mov_b32 v12, 0x3f803f80
    v_mov_b32 v13, 0x3f803f80
    s_nop 1
    v_mfma_f32_16x16x32_bf16 v[216:219], v[144:147], v[10:13], 0
    v_mfma_f32_16x16x32_bf16 v[220:223], v[148:151], v[10:13], 0
    v_mfma_f32_16x16x32_bf16 v[224:227], v[152:155], v[10:13], 0
    v_mfma_f32_16x16x32_bf16 v[228:231], v[156:159], v[10:13], 0
    v_mfma_f32_16x16x32_bf16 v[232:235], v[160:163], v[10:13], 0
    v_mfma_f32_16x16x32_bf16 v[236:239], v[164:167], v[10:13], 0
    v_mfma_f32_16x16x32_bf16 v[244:247], v[168:171], v[10:13], 0
    v_mfma_f32_16x16x32_bf16 v[216:219], v[188:191], v[10:13], v[216:219]
    v_mfma_f32_16x16x32_bf16 v[220:223], v[192:195], v[10:13], v[220:223]
    v_mfma_f32_16x16x32_bf16 v[224:227], v[196:199], v[10:13], v[224:227]
    v_mfma_f32_16x16x32_bf16 v[228:231], v[200:203], v[10:13], v[228:231]
    v_mfma_f32_16x16x32_bf16 v[232:235], v[204:207], v[10:13], v[232:235]
    v_mfma_f32_16x16x32_bf16 v[236:239], v[208:211], v[10:13], v[236:239]
    v_mfma_f32_16x16x32_bf16 v[244:247], v[212:215], v[10:13], v[244:247]
    s_mov_b32 exec_lo, 0x00010001
    s_mov_b32 exec_hi, 0x00010001
    ds_write_b128 v252, v[216:219] offset:0
    ds_write_b128 v252, v[220:223] offset:64
    ds_write_b128 v252, v[224:227] offset:128
    ds_write_b128 v252, v[228:231] offset:192
    ds_write_b128 v252, v[232:235] offset:256
    ds_write_b128 v252, v[236:239] offset:320
    ds_write_b128 v253, v[244:247]
    s_mov_b64 exec, -1
    s_branch L_csr0
L_cs1:
    v_mov_b32 v10, 0x3f803f80
    v_mov_b32 v11, 0x3f803f80
    v_mov_b32 v12, 0x3f803f80
    v_mov_b32 v13, 0x3f803f80
    s_nop 1
    v_mfma_f32_16x16x32_bf16 v[216:219], v[144:147], v[10:13], 0
    v_mfma_f32_16x16x32_bf16 v[220:223], v[148:151], v[10:13], 0
    v_mfma_f32_16x16x32_bf16 v[224:227], v[152:155], v[10:13], 0
    v_mfma_f32_16x16x32_bf16 v[228:231], v[156:159], v[10:13], 0
    v_mfma_f32_16x16x32_bf16 v[232:235], v[160:163], v[10:13], 0
    v_mfma_f32_16x16x32_bf16 v[236:239], v[164:167], v[10:13], 0
    v_mfma_f32_16x16x32_bf16 v[244:247], v[168:171], v[10:13], 0
    v_mfma_f32_16x16x32_bf16 v[216:219], v[188:191], v[10:13], v[216:219]
    v_mfma_f32_16x16x32_bf16 v[220:223], v[192:195], v[10:13], v[220:223]
    v_mfma_f32_16x16x32_bf16 v[224:227], v[196:199], v[10:13], v[224:227]
    v_mfma_f32_16x16x32_bf16 v[228:231], v[200:203], v[10:13], v[228:231]
    v_mfma_f32_16x16x32_bf16 v[232:235], v[204:207], v[10:13], v[232:235]
    v_mfma_f32_16x16x32_bf16 v[236:239], v[208:211], v[10:13], v[236:239]
    v_mfma_f32_16x16x32_bf16 v[244:247], v[212:215], v[10:13], v[244:247]
    s_mov_b32 exec_lo, 0x00010001
    s_mov_b32 exec_hi, 0x00010001
    ds_write_b128 v252, v[216:219] offset:0
    ds_write_b128 v252, v[220:223] offset:64
    ds_write_b128 v252, v[224:227] offset:128
    ds_write_b128 v252, v[228:231] offset:192
    ds_write_b128 v252, v[232:235] offset:256
    ds_write_b128 v252, v[236:239] offset:320
    ds_write_b128 v253, v[244:247]
    s_mov_b64 exec, -1
    s_branch L_csr1
L_cs2:
    v_mov_b32 v10, 0x3f803f80
    v_mov_b32 v11, 0x3f803f80
    v_mov_b32 v12, 0x3f803f80
    v_mov_b32 v13, 0x3f803f80
    s_nop 1
    v_mfma_f32_16x16x32_bf16 v[216:219], v[144:147], v[10:13], 0
    v_mfma_f32_16x16x32_bf16 v[220:223], v[148:151], v[10:13], 0
    v_mfma_f32_16x16x32_bf16 v[224:227], v[152:155], v[10:13], 0
    v_mfma_f32_16x16x32_bf16 v[228:231], v[156:159], v[10:13], 0
    v_mfma_f32_16x16x32_bf16 v[232:235], v[160:163], v[10:13], 0
    v_mfma_f32_16x16x32_bf16 v[236:239], v[164:167], v[10:13], 0
    v_mfma_f32_16x16x32_bf16 v[244:247], v[168:171], v[10:13], 0
    v_mfma_f32_16x16x32_bf16 v[216:219], v[188:191], v[10:13], v[216:219]
    v_mfma_f32_16x16x32_bf16 v[220:223], v[192:195], v[10:13], v[220:223]
    v_mfma_f32_16x16x32_bf16 v[224:227], v[196:199], v[10:13], v[224:227]
    v_mfma_f32_16x16x32_bf16 v[228:231], v[200:203], v[10:13], v[228:231]
    v_mfma_f32_16x16x32_bf16 v[232:235], v[204:207], v[10:13], v[232:235]
    v_mfma_f32_16x16x32_bf16 v[236:239], v[208:211], v[10:13], v[236:239]
    v_mfma_f32_16x16x32_bf16 v[244:247], v[212:215], v[10:13], v[244:247]
    s_mov_b32 exec_lo, 0x00010001
    s_mov_b32 exec_hi, 0x00010001
    ds_write_b128 v252, v[216:219] offset:0
    ds_write_b128 v252, v[220:223] offset:64
    ds_write_b128 v252, v[224:227] offset:128
    ds_write_b128 v252, v[228:231] offset:192
    ds_write_b128 v252, v[232:235] offset:256
    ds_write_b128 v252, v[236:239] offset:320
    ds_write_b128 v253, v[244:247]
    s_mov_b64 exec, -1
    s_branch L_csr2
L_end:
    s_endpgm
.section .rodata,"a"
.p2align 6
.amdhsa_kernel recurrent_scan__spectral_fnet__dense_activation_silu__prompt_kernel
  .amdhsa_next_free_vgpr 256
  .amdhsa_next_free_sgpr 102
  .amdhsa_accum_offset 256
  .amdhsa_group_segment_fixed_size 0
  .amdhsa_kernarg_size 88
  .amdhsa_user_sgpr_count 2
  .amdhsa_user_sgpr_kernarg_segment_ptr 1
  .amdhsa_system_sgpr_workgroup_id_x 1
.end_amdhsa_kernel
```
